```python
import torch

def _softmax(x, axis=-1):
    return torch.softmax(x, dim=axis)
def _gelu(x):
    return torch.nn.functional.gelu(x, approximate="tanh")
def _silu(x):
    return torch.nn.functional.silu(x)
def _sigmoid(x):
    return torch.sigmoid(x)
def _layernorm(x, axis=-1, eps=1e-5):
    m = x.mean(dim=axis, keepdim=True)
    v = x.var(dim=axis, keepdim=True, unbiased=False)
    return (x - m) / torch.sqrt(v + eps)
def _scatter_add(tgt, idx, src, axis=0):
    return tgt.clone().index_add_(axis, idx, src)
def _segment_sum(src, seg, n):
    out = torch.zeros((n,) + src.shape[1:], dtype=src.dtype)
    return out.index_add_(0, seg, src)
def _pad(x, pw):
    flat = tuple(v for pair in reversed(pw) for v in pair)
    return torch.nn.functional.pad(x, flat)

kernel_name = 'standalone__structured_sparse_n_m__ragged'

def setup_inputs():

    _w = (lambda a: (lambda t: t.to(torch.bfloat16) if t.is_floating_point() else t)(torch.as_tensor(a)))
    B, S, D = 4, 4096, 1024
    assert D % 4 == 0, "d_model must be divisible by M=4 for 2:4 sparsity"
    return {
        "x": _w((lambda *s: torch.randn(*s, dtype=torch.bfloat16) * 0.05)(B, S, D)),
        "w": _w((lambda *s: torch.randn(*s, dtype=torch.bfloat16) * 0.05)(D, D)),
        "b": _w((lambda *s: torch.randn(*s, dtype=torch.bfloat16) * 0.05)(D)),
    }

def reference(x, w, b):
    B, S, D = x.shape
    N, M = 2, 4
    G = D // M
    wg = w.reshape(G, M, D)
    mag = torch.abs(wg)
    order = torch.argsort(mag, 1)
    thr = (lambda x, i, axis: torch.take_along_dim(x, i, dim=axis))(mag, order[:, M - N:M - N + 1, :], 1)
    mask = (lambda x, dt: x.to(dt))(mag >= thr, w.dtype)
    wp = (wg * mask).reshape(D, D)
    return torch.einsum("bsd,df->bsf", x, wp) + b
```

```asm
; @launch kernel=prep_kernel grid=(256,1,1) block=(256,1,1) lds=256
; @launch kernel=standalone__structured_sparse_n_m__ragged_kernel grid=(256,1,1) block=(256,1,1) lds=163840
.amdgcn_target "amdgcn-amd-amdhsa--gfx950"
.text
.globl prep_kernel
.p2align 8
.type prep_kernel,@function
prep_kernel:
  s_cmp_ge_u32 s2, 256
  s_cbranch_scc1 Lp_end
  s_load_dwordx2 s[4:5], s[0:1], 8
  s_load_dwordx2 s[6:7], s[0:1], 40
  v_lshrrev_b32 v1, 6, v0
  v_and_b32 v2, 63, v0
  v_readfirstlane_b32 s3, v1
  s_lshr_b32 s8, s2, 4
  s_and_b32 s10, s2, 15
  s_mov_b32 s11, s3
  s_lshl_b32 s12, s10, 6
  s_lshl_b32 s13, s11, 4
  s_add_u32 s12, s12, s13
  s_lshl_b32 s13, s12, 11
  s_lshl_b32 s14, s8, 7
  s_add_u32 s13, s13, s14
  v_lshlrev_b32 v3, 1, v2
  s_waitcnt lgkmcnt(0)
  s_mov_b32 s16, s4
  s_mov_b32 s17, s5
  s_mov_b32 s18, 0x200000
  s_mov_b32 s19, 0x00020000
  s_mov_b32 s20, s6
  s_mov_b32 s21, s7
  s_mov_b32 s22, 8388608
  s_mov_b32 s23, 0x00020000
  buffer_load_ushort v4, v3, s[16:19], s13 offen nt
  buffer_load_ushort v12, v3, s[16:19], s13 offen offset:2048 nt
  s_add_u32 s13, s13, 4096
  buffer_load_ushort v5, v3, s[16:19], s13 offen nt
  buffer_load_ushort v13, v3, s[16:19], s13 offen offset:2048 nt
  s_add_u32 s13, s13, 4096
  buffer_load_ushort v6, v3, s[16:19], s13 offen nt
  buffer_load_ushort v14, v3, s[16:19], s13 offen offset:2048 nt
  s_add_u32 s13, s13, 4096
  buffer_load_ushort v7, v3, s[16:19], s13 offen nt
  buffer_load_ushort v15, v3, s[16:19], s13 offen offset:2048 nt
  s_add_u32 s13, s13, 4096
  buffer_load_ushort v8, v3, s[16:19], s13 offen nt
  buffer_load_ushort v16, v3, s[16:19], s13 offen offset:2048 nt
  s_add_u32 s13, s13, 4096
  buffer_load_ushort v9, v3, s[16:19], s13 offen nt
  buffer_load_ushort v17, v3, s[16:19], s13 offen offset:2048 nt
  s_add_u32 s13, s13, 4096
  buffer_load_ushort v10, v3, s[16:19], s13 offen nt
  buffer_load_ushort v18, v3, s[16:19], s13 offen offset:2048 nt
  s_add_u32 s13, s13, 4096
  buffer_load_ushort v11, v3, s[16:19], s13 offen nt
  buffer_load_ushort v19, v3, s[16:19], s13 offen offset:2048 nt
  v_lshrrev_b32 v40, 5, v2
  v_bfe_u32 v41, v2, 2, 1
  v_lshl_or_b32 v40, v40, 1, v41
  v_bfe_u32 v41, v2, 3, 2
  v_and_b32 v42, 3, v2
  v_lshl_or_b32 v41, v41, 2, v42
  v_lshlrev_b32 v42, 10, v40
  v_lshl_add_u32 v42, v41, 4, v42
  s_lshl_b32 s24, s8, 4
  s_add_u32 s24, s24, s10
  s_lshl_b32 s24, s24, 12
  s_lshr_b32 s25, s11, 1
  s_lshl_b32 s25, s25, 8
  s_add_u32 s24, s24, s25
  s_and_b32 s25, s11, 1
  s_lshl_b32 s26, s25, 3
  s_add_u32 s24, s24, s26
  v_lshlrev_b32 v43, 11, v40
  v_lshl_add_u32 v43, v41, 4, v43
  s_lshl_b32 s26, s8, 13
  s_add_u32 s26, s26, 1048576
  s_lshr_b32 s27, s10, 3
  s_lshl_b32 s27, s27, 10
  s_add_u32 s26, s26, s27
  s_lshr_b32 s27, s11, 1
  s_lshl_b32 s27, s27, 8
  s_add_u32 s26, s26, s27
  s_lshr_b32 s27, s10, 1
  s_and_b32 s27, s27, 3
  s_lshl_b32 s27, s27, 2
  s_add_u32 s26, s26, s27
  s_and_b32 s27, s10, 1
  s_lshl_b32 s27, s27, 1
  s_add_u32 s26, s26, s27
  s_add_u32 s26, s26, s25
  v_lshlrev_b32 v44, 16, v2
  v_mov_b32 v28, 0
  v_mov_b32 v29, 0
  v_mov_b32 v30, 0
  v_mov_b32 v31, 0
  v_mov_b32 v32, 0
  v_mov_b32 v33, 0
  v_mov_b32 v34, 0
  v_mov_b32 v35, 0
  s_waitcnt vmcnt(0)
  v_lshl_or_b32 v4, v12, 16, v4
  v_lshl_or_b32 v5, v13, 16, v5
  v_lshl_or_b32 v6, v14, 16, v6
  v_lshl_or_b32 v7, v15, 16, v7
  v_lshl_or_b32 v8, v16, 16, v8
  v_lshl_or_b32 v9, v17, 16, v9
  v_lshl_or_b32 v10, v18, 16, v10
  v_lshl_or_b32 v11, v19, 16, v11
  v_and_b32 v46, 0x7fff, v4
  v_bfe_u32 v47, v4, 16, 15
  v_and_b32 v48, 0x7fff, v5
  v_bfe_u32 v49, v5, 16, 15
  v_max_u32 v50, v46, v47
  v_min_u32 v51, v46, v47
  v_max_u32 v52, v48, v49
  v_min_u32 v53, v48, v49
  v_min_u32 v54, v50, v52
  v_max3_u32 v55, v54, v51, v53
  v_add_u32 v55, -1, v55
  v_sub_u32 v46, v55, v46
  v_sub_u32 v47, v55, v47
  v_sub_u32 v48, v55, v48
  v_sub_u32 v49, v55, v49
  v_lshrrev_b32 v56, 31, v46
  v_lshrrev_b32 v47, 30, v47
  v_and_or_b32 v56, v47, 2, v56
  v_lshrrev_b32 v48, 29, v48
  v_and_or_b32 v56, v48, 4, v56
  v_lshrrev_b32 v49, 28, v49
  v_and_or_b32 v56, v49, 8, v56
  v_ffbl_b32 v57, v56
  v_add_u32 v54, -1, v56
  v_and_b32 v59, v56, v54
  v_ffbl_b32 v58, v59
  v_add_u32 v54, -1, v59
  v_and_b32 v60, v59, v54
  v_cmp_ne_u32 vcc, 0, v60
  v_lshlrev_b32 v54, 4, v57
  v_lshrrev_b64 v[62:63], v54, v[4:5]
  v_and_b32 v46, 0xffff, v62
  v_lshlrev_b32 v54, 4, v58
  v_lshrrev_b64 v[62:63], v54, v[4:5]
  v_lshl_or_b32 v20, v62, 16, v46
  v_lshl_or_b32 v24, v58, 2, v57
  s_cmp_eq_u64 vcc, 0
  s_cbranch_scc1 Lp_nores0
  v_ffbl_b32 v57, v60
  v_lshlrev_b32 v54, 4, v57
  v_lshrrev_b64 v[62:63], v54, v[4:5]
  v_and_b32 v46, 0xffff, v62
  v_and_b32 v47, 0x7fff, v62
  v_min_u32 v47, v47, v60
  v_add_u32 v48, s12, v57
  v_add_u32 v48, 0, v48
  v_lshl_or_b32 v48, v48, 22, v44
  v_or_b32 v48, v48, v46
  v_cmp_ne_u32 vcc, 0, v47
  v_add_u32 v54, -1, v60
  v_and_b32 v59, v60, v54
  v_cndmask_b32 v28, 0, v48, vcc
  v_ffbl_b32 v57, v59
  v_lshlrev_b32 v54, 4, v57
  v_lshrrev_b64 v[62:63], v54, v[4:5]
  v_and_b32 v46, 0xffff, v62
  v_and_b32 v47, 0x7fff, v62
  v_min_u32 v47, v47, v59
  v_add_u32 v48, s12, v57
  v_add_u32 v48, 0, v48
  v_lshl_or_b32 v48, v48, 22, v44
  v_or_b32 v48, v48, v46
  v_cmp_ne_u32 vcc, 0, v47
  s_nop 1
  v_cndmask_b32 v29, 0, v48, vcc
Lp_nores0:
  v_and_b32 v46, 0x7fff, v6
  v_bfe_u32 v47, v6, 16, 15
  v_and_b32 v48, 0x7fff, v7
  v_bfe_u32 v49, v7, 16, 15
  v_max_u32 v50, v46, v47
  v_min_u32 v51, v46, v47
  v_max_u32 v52, v48, v49
  v_min_u32 v53, v48, v49
  v_min_u32 v54, v50, v52
  v_max3_u32 v55, v54, v51, v53
  v_add_u32 v55, -1, v55
  v_sub_u32 v46, v55, v46
  v_sub_u32 v47, v55, v47
  v_sub_u32 v48, v55, v48
  v_sub_u32 v49, v55, v49
  v_lshrrev_b32 v56, 31, v46
  v_lshrrev_b32 v47, 30, v47
  v_and_or_b32 v56, v47, 2, v56
  v_lshrrev_b32 v48, 29, v48
  v_and_or_b32 v56, v48, 4, v56
  v_lshrrev_b32 v49, 28, v49
  v_and_or_b32 v56, v49, 8, v56
  v_ffbl_b32 v57, v56
  v_add_u32 v54, -1, v56
  v_and_b32 v59, v56, v54
  v_ffbl_b32 v58, v59
  v_add_u32 v54, -1, v59
  v_and_b32 v60, v59, v54
  v_cmp_ne_u32 vcc, 0, v60
  v_lshlrev_b32 v54, 4, v57
  v_lshrrev_b64 v[62:63], v54, v[6:7]
  v_and_b32 v46, 0xffff, v62
  v_lshlrev_b32 v54, 4, v58
  v_lshrrev_b64 v[62:63], v54, v[6:7]
  v_lshl_or_b32 v21, v62, 16, v46
  v_lshl_or_b32 v25, v58, 2, v57
  s_cmp_eq_u64 vcc, 0
  s_cbranch_scc1 Lp_nores1
  v_ffbl_b32 v57, v60
  v_lshlrev_b32 v54, 4, v57
  v_lshrrev_b64 v[62:63], v54, v[6:7]
  v_and_b32 v46, 0xffff, v62
  v_and_b32 v47, 0x7fff, v62
  v_min_u32 v47, v47, v60
  v_add_u32 v48, s12, v57
  v_add_u32 v48, 4, v48
  v_lshl_or_b32 v48, v48, 22, v44
  v_or_b32 v48, v48, v46
  v_cmp_ne_u32 vcc, 0, v47
  v_add_u32 v54, -1, v60
  v_and_b32 v59, v60, v54
  v_cndmask_b32 v30, 0, v48, vcc
  v_ffbl_b32 v57, v59
  v_lshlrev_b32 v54, 4, v57
  v_lshrrev_b64 v[62:63], v54, v[6:7]
  v_and_b32 v46, 0xffff, v62
  v_and_b32 v47, 0x7fff, v62
  v_min_u32 v47, v47, v59
  v_add_u32 v48, s12, v57
  v_add_u32 v48, 4, v48
  v_lshl_or_b32 v48, v48, 22, v44
  v_or_b32 v48, v48, v46
  v_cmp_ne_u32 vcc, 0, v47
  s_nop 1
  v_cndmask_b32 v31, 0, v48, vcc
Lp_nores1:
  v_and_b32 v46, 0x7fff, v8
  v_bfe_u32 v47, v8, 16, 15
  v_and_b32 v48, 0x7fff, v9
  v_bfe_u32 v49, v9, 16, 15
  v_max_u32 v50, v46, v47
  v_min_u32 v51, v46, v47
  v_max_u32 v52, v48, v49
  v_min_u32 v53, v48, v49
  v_min_u32 v54, v50, v52
  v_max3_u32 v55, v54, v51, v53
  v_add_u32 v55, -1, v55
  v_sub_u32 v46, v55, v46
  v_sub_u32 v47, v55, v47
  v_sub_u32 v48, v55, v48
  v_sub_u32 v49, v55, v49
  v_lshrrev_b32 v56, 31, v46
  v_lshrrev_b32 v47, 30, v47
  v_and_or_b32 v56, v47, 2, v56
  v_lshrrev_b32 v48, 29, v48
  v_and_or_b32 v56, v48, 4, v56
  v_lshrrev_b32 v49, 28, v49
  v_and_or_b32 v56, v49, 8, v56
  v_ffbl_b32 v57, v56
  v_add_u32 v54, -1, v56
  v_and_b32 v59, v56, v54
  v_ffbl_b32 v58, v59
  v_add_u32 v54, -1, v59
  v_and_b32 v60, v59, v54
  v_cmp_ne_u32 vcc, 0, v60
  v_lshlrev_b32 v54, 4, v57
  v_lshrrev_b64 v[62:63], v54, v[8:9]
  v_and_b32 v46, 0xffff, v62
  v_lshlrev_b32 v54, 4, v58
  v_lshrrev_b64 v[62:63], v54, v[8:9]
  v_lshl_or_b32 v22, v62, 16, v46
  v_lshl_or_b32 v26, v58, 2, v57
  s_cmp_eq_u64 vcc, 0
  s_cbranch_scc1 Lp_nores2
  v_ffbl_b32 v57, v60
  v_lshlrev_b32 v54, 4, v57
  v_lshrrev_b64 v[62:63], v54, v[8:9]
  v_and_b32 v46, 0xffff, v62
  v_and_b32 v47, 0x7fff, v62
  v_min_u32 v47, v47, v60
  v_add_u32 v48, s12, v57
  v_add_u32 v48, 8, v48
  v_lshl_or_b32 v48, v48, 22, v44
  v_or_b32 v48, v48, v46
  v_cmp_ne_u32 vcc, 0, v47
  v_add_u32 v54, -1, v60
  v_and_b32 v59, v60, v54
  v_cndmask_b32 v32, 0, v48, vcc
  v_ffbl_b32 v57, v59
  v_lshlrev_b32 v54, 4, v57
  v_lshrrev_b64 v[62:63], v54, v[8:9]
  v_and_b32 v46, 0xffff, v62
  v_and_b32 v47, 0x7fff, v62
  v_min_u32 v47, v47, v59
  v_add_u32 v48, s12, v57
  v_add_u32 v48, 8, v48
  v_lshl_or_b32 v48, v48, 22, v44
  v_or_b32 v48, v48, v46
  v_cmp_ne_u32 vcc, 0, v47
  s_nop 1
  v_cndmask_b32 v33, 0, v48, vcc
Lp_nores2:
  v_and_b32 v46, 0x7fff, v10
  v_bfe_u32 v47, v10, 16, 15
  v_and_b32 v48, 0x7fff, v11
  v_bfe_u32 v49, v11, 16, 15
  v_max_u32 v50, v46, v47
  v_min_u32 v51, v46, v47
  v_max_u32 v52, v48, v49
  v_min_u32 v53, v48, v49
  v_min_u32 v54, v50, v52
  v_max3_u32 v55, v54, v51, v53
  v_add_u32 v55, -1, v55
  v_sub_u32 v46, v55, v46
  v_sub_u32 v47, v55, v47
  v_sub_u32 v48, v55, v48
  v_sub_u32 v49, v55, v49
  v_lshrrev_b32 v56, 31, v46
  v_lshrrev_b32 v47, 30, v47
  v_and_or_b32 v56, v47, 2, v56
  v_lshrrev_b32 v48, 29, v48
  v_and_or_b32 v56, v48, 4, v56
  v_lshrrev_b32 v49, 28, v49
  v_and_or_b32 v56, v49, 8, v56
  v_ffbl_b32 v57, v56
  v_add_u32 v54, -1, v56
  v_and_b32 v59, v56, v54
  v_ffbl_b32 v58, v59
  v_add_u32 v54, -1, v59
  v_and_b32 v60, v59, v54
  v_cmp_ne_u32 vcc, 0, v60
  v_lshlrev_b32 v54, 4, v57
  v_lshrrev_b64 v[62:63], v54, v[10:11]
  v_and_b32 v46, 0xffff, v62
  v_lshlrev_b32 v54, 4, v58
  v_lshrrev_b64 v[62:63], v54, v[10:11]
  v_lshl_or_b32 v23, v62, 16, v46
  v_lshl_or_b32 v27, v58, 2, v57
  s_cmp_eq_u64 vcc, 0
  s_cbranch_scc1 Lp_nores3
  v_ffbl_b32 v57, v60
  v_lshlrev_b32 v54, 4, v57
  v_lshrrev_b64 v[62:63], v54, v[10:11]
  v_and_b32 v46, 0xffff, v62
  v_and_b32 v47, 0x7fff, v62
  v_min_u32 v47, v47, v60
  v_add_u32 v48, s12, v57
  v_add_u32 v48, 12, v48
  v_lshl_or_b32 v48, v48, 22, v44
  v_or_b32 v48, v48, v46
  v_cmp_ne_u32 vcc, 0, v47
  v_add_u32 v54, -1, v60
  v_and_b32 v59, v60, v54
  v_cndmask_b32 v34, 0, v48, vcc
  v_ffbl_b32 v57, v59
  v_lshlrev_b32 v54, 4, v57
  v_lshrrev_b64 v[62:63], v54, v[10:11]
  v_and_b32 v46, 0xffff, v62
  v_and_b32 v47, 0x7fff, v62
  v_min_u32 v47, v47, v59
  v_add_u32 v48, s12, v57
  v_add_u32 v48, 12, v48
  v_lshl_or_b32 v48, v48, 22, v44
  v_or_b32 v48, v48, v46
  v_cmp_ne_u32 vcc, 0, v47
  s_nop 1
  v_cndmask_b32 v35, 0, v48, vcc
Lp_nores3:
  buffer_store_dwordx2 v[20:21], v42, s[20:23], s24 offen offset:0
  v_lshl_or_b32 v46, v25, 4, v24
  buffer_store_byte v46, v43, s[20:23], s26 offen offset:0
  buffer_store_dwordx2 v[22:23], v42, s[20:23], s24 offen offset:512
  v_lshl_or_b32 v47, v27, 4, v26
  buffer_store_byte v47, v43, s[20:23], s26 offen offset:512
  s_mov_b32 s28, 0
  v_cmp_ne_u32 s[32:33], 0, v28
  v_cmp_ne_u32 s[34:35], 0, v29
  v_cmp_ne_u32 s[36:37], 0, v30
  v_cmp_ne_u32 s[38:39], 0, v31
  v_cmp_ne_u32 s[40:41], 0, v32
  v_cmp_ne_u32 s[42:43], 0, v33
  v_cmp_ne_u32 s[44:45], 0, v34
  v_cmp_ne_u32 s[46:47], 0, v35
  s_nop 3
  s_bcnt1_i32_b64 s29, s[32:33]
  s_add_u32 s28, s28, s29
  s_bcnt1_i32_b64 s29, s[34:35]
  s_add_u32 s28, s28, s29
  s_bcnt1_i32_b64 s29, s[36:37]
  s_add_u32 s28, s28, s29
  s_bcnt1_i32_b64 s29, s[38:39]
  s_add_u32 s28, s28, s29
  s_bcnt1_i32_b64 s29, s[40:41]
  s_add_u32 s28, s28, s29
  s_bcnt1_i32_b64 s29, s[42:43]
  s_add_u32 s28, s28, s29
  s_bcnt1_i32_b64 s29, s[44:45]
  s_add_u32 s28, s28, s29
  s_bcnt1_i32_b64 s29, s[46:47]
  s_add_u32 s28, s28, s29
  v_mov_b32 v46, s28
  s_lshl_b32 s29, s3, 2
  v_mov_b32 v47, s29
  ds_write_b32 v47, v46
  v_mov_b32 v47, 0
  s_waitcnt lgkmcnt(0)
  s_barrier
  ds_read_b128 v[48:51], v47
  s_waitcnt lgkmcnt(0)
  s_mov_b32 s28, 0
  s_mov_b32 s30, 0
  v_readfirstlane_b32 s29, v48
  s_add_u32 s30, s30, s29
  s_cmp_gt_u32 s3, 0
  s_cselect_b32 s29, s29, 0
  s_add_u32 s28, s28, s29
  v_readfirstlane_b32 s29, v49
  s_add_u32 s30, s30, s29
  s_cmp_gt_u32 s3, 1
  s_cselect_b32 s29, s29, 0
  s_add_u32 s28, s28, s29
  v_readfirstlane_b32 s29, v50
  s_add_u32 s30, s30, s29
  s_cmp_gt_u32 s3, 2
  s_cselect_b32 s29, s29, 0
  s_add_u32 s28, s28, s29
  v_readfirstlane_b32 s29, v51
  s_add_u32 s30, s30, s29
  s_cmp_gt_u32 s3, 3
  s_cselect_b32 s29, s29, 0
  s_add_u32 s28, s28, s29
  s_lshl_b32 s31, s2, 14
  s_add_u32 s31, s31, 2097152
  s_cmp_eq_u64 s[32:33], 0
  s_cbranch_scc1 Lp_skip0
  v_mbcnt_lo_u32_b32 v46, s32, 0
  v_mbcnt_hi_u32_b32 v46, s33, v46
  v_add_u32 v46, s28, v46
  v_lshrrev_b32 v47, 1, v46
  v_lshlrev_b32 v47, 4, v47
  v_and_b32 v46, 1, v46
  v_lshl_add_u32 v48, v46, 2, v47
  v_lshl_add_u32 v49, v46, 1, v47
  v_lshrrev_b32 v50, 21, v28
  v_and_b32 v50, 0x7fe, v50
  v_bfe_u32 v51, v28, 16, 6
  s_mov_b64 exec, s[32:33]
  buffer_store_dword v50, v48, s[20:23], s31 offen
  buffer_store_short v28, v49, s[20:23], s31 offen offset:8
  buffer_store_short v51, v49, s[20:23], s31 offen offset:12
  s_mov_b64 exec, -1
  s_bcnt1_i32_b64 s29, s[32:33]
  s_add_u32 s28, s28, s29
Lp_skip0:
  s_cmp_eq_u64 s[34:35], 0
  s_cbranch_scc1 Lp_skip1
  v_mbcnt_lo_u32_b32 v46, s34, 0
  v_mbcnt_hi_u32_b32 v46, s35, v46
  v_add_u32 v46, s28, v46
  v_lshrrev_b32 v47, 1, v46
  v_lshlrev_b32 v47, 4, v47
  v_and_b32 v46, 1, v46
  v_lshl_add_u32 v48, v46, 2, v47
  v_lshl_add_u32 v49, v46, 1, v47
  v_lshrrev_b32 v50, 21, v29
  v_and_b32 v50, 0x7fe, v50
  v_bfe_u32 v51, v29, 16, 6
  s_mov_b64 exec, s[34:35]
  buffer_store_dword v50, v48, s[20:23], s31 offen
  buffer_store_short v29, v49, s[20:23], s31 offen offset:8
  buffer_store_short v51, v49, s[20:23], s31 offen offset:12
  s_mov_b64 exec, -1
  s_bcnt1_i32_b64 s29, s[34:35]
  s_add_u32 s28, s28, s29
Lp_skip1:
  s_cmp_eq_u64 s[36:37], 0
  s_cbranch_scc1 Lp_skip2
  v_mbcnt_lo_u32_b32 v46, s36, 0
  v_mbcnt_hi_u32_b32 v46, s37, v46
  v_add_u32 v46, s28, v46
  v_lshrrev_b32 v47, 1, v46
  v_lshlrev_b32 v47, 4, v47
  v_and_b32 v46, 1, v46
  v_lshl_add_u32 v48, v46, 2, v47
  v_lshl_add_u32 v49, v46, 1, v47
  v_lshrrev_b32 v50, 21, v30
  v_and_b32 v50, 0x7fe, v50
  v_bfe_u32 v51, v30, 16, 6
  s_mov_b64 exec, s[36:37]
  buffer_store_dword v50, v48, s[20:23], s31 offen
  buffer_store_short v30, v49, s[20:23], s31 offen offset:8
  buffer_store_short v51, v49, s[20:23], s31 offen offset:12
  s_mov_b64 exec, -1
  s_bcnt1_i32_b64 s29, s[36:37]
  s_add_u32 s28, s28, s29
Lp_skip2:
  s_cmp_eq_u64 s[38:39], 0
  s_cbranch_scc1 Lp_skip3
  v_mbcnt_lo_u32_b32 v46, s38, 0
  v_mbcnt_hi_u32_b32 v46, s39, v46
  v_add_u32 v46, s28, v46
  v_lshrrev_b32 v47, 1, v46
  v_lshlrev_b32 v47, 4, v47
  v_and_b32 v46, 1, v46
  v_lshl_add_u32 v48, v46, 2, v47
  v_lshl_add_u32 v49, v46, 1, v47
  v_lshrrev_b32 v50, 21, v31
  v_and_b32 v50, 0x7fe, v50
  v_bfe_u32 v51, v31, 16, 6
  s_mov_b64 exec, s[38:39]
  buffer_store_dword v50, v48, s[20:23], s31 offen
  buffer_store_short v31, v49, s[20:23], s31 offen offset:8
  buffer_store_short v51, v49, s[20:23], s31 offen offset:12
  s_mov_b64 exec, -1
  s_bcnt1_i32_b64 s29, s[38:39]
  s_add_u32 s28, s28, s29
Lp_skip3:
  s_cmp_eq_u64 s[40:41], 0
  s_cbranch_scc1 Lp_skip4
  v_mbcnt_lo_u32_b32 v46, s40, 0
  v_mbcnt_hi_u32_b32 v46, s41, v46
  v_add_u32 v46, s28, v46
  v_lshrrev_b32 v47, 1, v46
  v_lshlrev_b32 v47, 4, v47
  v_and_b32 v46, 1, v46
  v_lshl_add_u32 v48, v46, 2, v47
  v_lshl_add_u32 v49, v46, 1, v47
  v_lshrrev_b32 v50, 21, v32
  v_and_b32 v50, 0x7fe, v50
  v_bfe_u32 v51, v32, 16, 6
  s_mov_b64 exec, s[40:41]
  buffer_store_dword v50, v48, s[20:23], s31 offen
  buffer_store_short v32, v49, s[20:23], s31 offen offset:8
  buffer_store_short v51, v49, s[20:23], s31 offen offset:12
  s_mov_b64 exec, -1
  s_bcnt1_i32_b64 s29, s[40:41]
  s_add_u32 s28, s28, s29
Lp_skip4:
  s_cmp_eq_u64 s[42:43], 0
  s_cbranch_scc1 Lp_skip5
  v_mbcnt_lo_u32_b32 v46, s42, 0
  v_mbcnt_hi_u32_b32 v46, s43, v46
  v_add_u32 v46, s28, v46
  v_lshrrev_b32 v47, 1, v46
  v_lshlrev_b32 v47, 4, v47
  v_and_b32 v46, 1, v46
  v_lshl_add_u32 v48, v46, 2, v47
  v_lshl_add_u32 v49, v46, 1, v47
  v_lshrrev_b32 v50, 21, v33
  v_and_b32 v50, 0x7fe, v50
  v_bfe_u32 v51, v33, 16, 6
  s_mov_b64 exec, s[42:43]
  buffer_store_dword v50, v48, s[20:23], s31 offen
  buffer_store_short v33, v49, s[20:23], s31 offen offset:8
  buffer_store_short v51, v49, s[20:23], s31 offen offset:12
  s_mov_b64 exec, -1
  s_bcnt1_i32_b64 s29, s[42:43]
  s_add_u32 s28, s28, s29
Lp_skip5:
  s_cmp_eq_u64 s[44:45], 0
  s_cbranch_scc1 Lp_skip6
  v_mbcnt_lo_u32_b32 v46, s44, 0
  v_mbcnt_hi_u32_b32 v46, s45, v46
  v_add_u32 v46, s28, v46
  v_lshrrev_b32 v47, 1, v46
  v_lshlrev_b32 v47, 4, v47
  v_and_b32 v46, 1, v46
  v_lshl_add_u32 v48, v46, 2, v47
  v_lshl_add_u32 v49, v46, 1, v47
  v_lshrrev_b32 v50, 21, v34
  v_and_b32 v50, 0x7fe, v50
  v_bfe_u32 v51, v34, 16, 6
  s_mov_b64 exec, s[44:45]
  buffer_store_dword v50, v48, s[20:23], s31 offen
  buffer_store_short v34, v49, s[20:23], s31 offen offset:8
  buffer_store_short v51, v49, s[20:23], s31 offen offset:12
  s_mov_b64 exec, -1
  s_bcnt1_i32_b64 s29, s[44:45]
  s_add_u32 s28, s28, s29
Lp_skip6:
  s_cmp_eq_u64 s[46:47], 0
  s_cbranch_scc1 Lp_skip7
  v_mbcnt_lo_u32_b32 v46, s46, 0
  v_mbcnt_hi_u32_b32 v46, s47, v46
  v_add_u32 v46, s28, v46
  v_lshrrev_b32 v47, 1, v46
  v_lshlrev_b32 v47, 4, v47
  v_and_b32 v46, 1, v46
  v_lshl_add_u32 v48, v46, 2, v47
  v_lshl_add_u32 v49, v46, 1, v47
  v_lshrrev_b32 v50, 21, v35
  v_and_b32 v50, 0x7fe, v50
  v_bfe_u32 v51, v35, 16, 6
  s_mov_b64 exec, s[46:47]
  buffer_store_dword v50, v48, s[20:23], s31 offen
  buffer_store_short v35, v49, s[20:23], s31 offen offset:8
  buffer_store_short v51, v49, s[20:23], s31 offen offset:12
  s_mov_b64 exec, -1
  s_bcnt1_i32_b64 s29, s[46:47]
  s_add_u32 s28, s28, s29
Lp_skip7:
  s_cmp_lg_u32 s3, 0
  s_cbranch_scc1 Lp_end
  s_add_u32 s29, s30, 1
  s_lshr_b32 s29, s29, 1
  v_mov_b32 v51, s29
  v_mov_b32 v50, 0
  s_mov_b64 exec, 1
  s_bitcmp0_b32 s30, 0
  s_cbranch_scc1 Lp_nopad
  s_lshr_b32 s28, s30, 1
  s_lshl_b32 s28, s28, 4
  v_mov_b32 v48, s28
  buffer_store_dword v50, v48, s[20:23], s31 offen offset:4
  buffer_store_short v50, v48, s[20:23], s31 offen offset:10
  buffer_store_short v50, v48, s[20:23], s31 offen offset:14
Lp_nopad:
  s_lshl_b32 s29, s2, 2
  s_add_u32 s29, s29, 1179648
  buffer_store_dword v51, v50, s[20:23], s29 offen
Lp_end:
  s_endpgm
.globl standalone__structured_sparse_n_m__ragged_kernel
.p2align 8
.type standalone__structured_sparse_n_m__ragged_kernel,@function
standalone__structured_sparse_n_m__ragged_kernel:
  s_cmp_ge_u32 s2, 256
  s_cbranch_scc1 Lm_end
  s_load_dwordx4 s[4:7], s[0:1], 0
  s_load_dwordx4 s[8:11], s[0:1], 16
  s_load_dwordx2 s[14:15], s[0:1], 40
  v_lshrrev_b32 v3, 6, v0
  v_and_b32 v233, 63, v0
  v_readfirstlane_b32 s32, v3
  v_and_b32 v1, 15, v233
  v_lshrrev_b32 v2, 4, v233
  v_lshlrev_b32 v255, 4, v233
  s_and_b32 s52, s2, 7
  s_lshr_b32 s53, s2, 3
  s_and_b32 s54, s53, 3
  s_lshr_b32 s53, s53, 2
  s_lshl_b32 s53, s53, 3
  s_add_u32 s53, s53, s52
  s_lshl_b32 s56, s53, 19
  s_lshl_b32 s33, s54, 2
  s_add_u32 s33, s33, s32
  s_mul_i32 s60, s32, 40960
  s_add_u32 s61, s60, 10240
  s_add_u32 s62, s60, 20480
  s_add_u32 s63, s60, 30720
  s_mov_b32 s64, 0x00010001
  s_mov_b32 s65, -1
  s_lshl_b32 s52, s32, 2
  s_add_u32 s52, s52, 0
  v_xor_b32 v13, s52, v233
  v_and_b32 v13, 15, v13
  v_and_or_b32 v13, v233, 48, v13
  v_lshlrev_b32 v13, 4, v13
  s_lshl_b32 s53, s52, 11
  v_add_u32 v3, s53, v13
  s_lshl_b32 s52, s32, 2
  s_add_u32 s52, s52, 1
  v_xor_b32 v13, s52, v233
  v_and_b32 v13, 15, v13
  v_and_or_b32 v13, v233, 48, v13
  v_lshlrev_b32 v13, 4, v13
  s_lshl_b32 s53, s52, 11
  v_add_u32 v4, s53, v13
  s_lshl_b32 s52, s32, 2
  s_add_u32 s52, s52, 2
  v_xor_b32 v13, s52, v233
  v_and_b32 v13, 15, v13
  v_and_or_b32 v13, v233, 48, v13
  v_lshlrev_b32 v13, 4, v13
  s_lshl_b32 s53, s52, 11
  v_add_u32 v5, s53, v13
  s_lshl_b32 s52, s32, 2
  s_add_u32 s52, s52, 3
  v_xor_b32 v13, s52, v233
  v_and_b32 v13, 15, v13
  v_and_or_b32 v13, v233, 48, v13
  v_lshlrev_b32 v13, 4, v13
  s_lshl_b32 s53, s52, 11
  v_add_u32 v6, s53, v13
  s_waitcnt lgkmcnt(0)
  s_mov_b32 s16, s4
  s_mov_b32 s17, s5
  s_mov_b32 s18, 33554432
  s_mov_b32 s19, 0x00020000
  s_mov_b32 s20, s10
  s_mov_b32 s21, s11
  s_mov_b32 s22, 33554432
  s_mov_b32 s23, 0x00020000
  s_mov_b32 s24, s14
  s_mov_b32 s25, s15
  s_mov_b32 s26, 8388608
  s_mov_b32 s27, 0x00020000
  s_mov_b32 s28, s8
  s_mov_b32 s29, s9
  s_mov_b32 s30, 2048
  s_mov_b32 s31, 0x00020000
  s_lshl_b32 s52, s33, 6
  s_add_u32 s52, s52, 1179648
  s_load_dwordx16 s[80:95], s[14:15], s52
  s_lshr_b32 s40, s56, 19
  s_mul_i32 s40, s40, 32768
  s_and_b32 s40, s40, 0x7ffff
  s_mov_b32 s41, s40
  s_add_u32 s36, s56, s40
  s_mov_b32 s59, 0
  s_add_u32 m0, s60, 0
  s_nop 0
  buffer_load_dwordx4 v3, s[16:19], s36 offen offset:0 nt lds
  buffer_load_dwordx4 v3, s[16:19], s36 offen offset:1024 nt lds
  s_add_u32 m0, s61, 0
  s_nop 0
  buffer_load_dwordx4 v4, s[16:19], s36 offen offset:0 nt lds
  buffer_load_dwordx4 v4, s[16:19], s36 offen offset:1024 nt lds
  s_add_u32 m0, s62, 0
  s_nop 0
  buffer_load_dwordx4 v5, s[16:19], s36 offen offset:0 nt lds
  buffer_load_dwordx4 v5, s[16:19], s36 offen offset:1024 nt lds
  s_add_u32 m0, s63, 0
  s_nop 0
  buffer_load_dwordx4 v6, s[16:19], s36 offen offset:0 nt lds
  buffer_load_dwordx4 v6, s[16:19], s36 offen offset:1024 nt lds
  s_add_u32 s59, s59, 1
  s_add_u32 s40, s40, 32768
  s_and_b32 s40, s40, 0x7ffff
  s_add_u32 s36, s40, s56
  s_cmp_ge_u32 s59, 16
  s_cselect_b32 s36, 1073741824, s36
  s_lshl_b32 s52, s33, 13
  s_add_u32 s52, s52, 1048576
  buffer_load_dwordx4 v[16:19], v255, s[24:27], s52 offen offset:0
  buffer_load_dwordx4 v[20:23], v255, s[24:27], s52 offen offset:1024
  buffer_load_dwordx4 v[24:27], v255, s[24:27], s52 offen offset:2048
  buffer_load_dwordx4 v[28:31], v255, s[24:27], s52 offen offset:3072
  s_add_u32 s52, s52, 4096
  buffer_load_dwordx4 v[32:35], v255, s[24:27], s52 offen offset:0
  buffer_load_dwordx4 v[36:39], v255, s[24:27], s52 offen offset:1024
  buffer_load_dwordx4 v[40:43], v255, s[24:27], s52 offen offset:2048
  buffer_load_dwordx4 v[44:47], v255, s[24:27], s52 offen offset:3072
  v_lshlrev_b32 v13, 4, v2
  s_lshl_b32 s52, s33, 7
  buffer_load_dwordx4 v[224:227], v13, s[28:31], s52 offen offset:0
  buffer_load_dwordx4 v[228:231], v13, s[28:31], s52 offen offset:64
  s_lshl_b32 s66, s33, 16
  buffer_load_dwordx4 a[0:3], v255, s[24:27], s66 offen offset:0
  buffer_load_dwordx4 a[4:7], v255, s[24:27], s66 offen offset:1024
  buffer_load_dwordx4 a[8:11], v255, s[24:27], s66 offen offset:2048
  buffer_load_dwordx4 a[12:15], v255, s[24:27], s66 offen offset:3072
  s_add_u32 s66, s66, 4096
  buffer_load_dwordx4 a[16:19], v255, s[24:27], s66 offen offset:0
  buffer_load_dwordx4 a[20:23], v255, s[24:27], s66 offen offset:1024
  buffer_load_dwordx4 a[24:27], v255, s[24:27], s66 offen offset:2048
  buffer_load_dwordx4 a[28:31], v255, s[24:27], s66 offen offset:3072
  s_add_u32 s66, s66, 4096
  buffer_load_dwordx4 a[32:35], v255, s[24:27], s66 offen offset:0
  buffer_load_dwordx4 a[36:39], v255, s[24:27], s66 offen offset:1024
  buffer_load_dwordx4 a[40:43], v255, s[24:27], s66 offen offset:2048
  buffer_load_dwordx4 a[44:47], v255, s[24:27], s66 offen offset:3072
  s_add_u32 s66, s66, 4096
  v_and_b32 v7, 14, v1
  v_lshlrev_b32 v7, 11, v7
  v_lshl_add_u32 v7, v2, 4, v7
  v_and_b32 v13, 1, v1
  v_lshl_add_u32 v7, v13, 6, v7
  s_mov_b32 s48, 0x55555555
  s_mov_b32 s49, 0x55555555
  s_movk_i32 s52, 10240
  v_mul_lo_u32 v14, v1, s52
  v_lshlrev_b32 v13, 1, v2
  v_add_u32 v13, 0, v13
  v_xor_b32 v13, v13, v1
  v_lshl_add_u32 v8, v13, 4, v14
  v_lshlrev_b32 v13, 1, v2
  v_add_u32 v13, 1, v13
  v_xor_b32 v13, v13, v1
  v_lshl_add_u32 v9, v13, 4, v14
  v_lshlrev_b32 v13, 1, v2
  v_add_u32 v13, 8, v13
  v_xor_b32 v13, v13, v1
  v_lshl_add_u32 v10, v13, 4, v14
  v_lshlrev_b32 v13, 1, v2
  v_add_u32 v13, 9, v13
  v_xor_b32 v13, v13, v1
  v_lshl_add_u32 v11, v13, 4, v14
  v_lshl_or_b32 v12, v1, 4, v14
  v_mov_b32 v253, 0x44444444
  v_lshlrev_b32 v252, 4, v2
  v_and_b32 v235, 1, v2
  v_lshlrev_b32 v235, 5, v235
  v_lshrrev_b32 v13, 1, v2
  v_lshl_or_b32 v235, v13, 3, v235
  v_lshrrev_b32 v13, 2, v1
  v_and_b32 v0, 3, v1
  v_lshl_or_b32 v0, v13, 3, v0
  v_lshl_or_b32 v0, v0, 16, v0
  s_waitcnt lgkmcnt(0)
  v_lshlrev_b32 v254, 4, v233
  s_mov_b32 s44, -1
  s_add_u32 s44, s44, s80
  s_lshl_b32 s45, s80, 4
  s_sub_u32 s45, 16384, s45
  v_sub_u32 v15, s44, v233
  v_ashrrev_i32 v15, 31, v15
  v_and_b32 v15, s45, v15
  v_add_u32 v254, v254, v15
  s_add_u32 s44, s44, s81
  s_lshl_b32 s45, s81, 4
  s_sub_u32 s45, 16384, s45
  v_sub_u32 v15, s44, v233
  v_ashrrev_i32 v15, 31, v15
  v_and_b32 v15, s45, v15
  v_add_u32 v254, v254, v15
  s_add_u32 s44, s44, s82
  s_lshl_b32 s45, s82, 4
  s_sub_u32 s45, 16384, s45
  v_sub_u32 v15, s44, v233
  v_ashrrev_i32 v15, 31, v15
  v_and_b32 v15, s45, v15
  v_add_u32 v254, v254, v15
  s_add_u32 s44, s44, s83
  s_lshl_b32 s45, s83, 4
  s_sub_u32 s45, 16384, s45
  v_sub_u32 v15, s44, v233
  v_ashrrev_i32 v15, 31, v15
  v_and_b32 v15, s45, v15
  v_add_u32 v254, v254, v15
  s_add_u32 s44, s44, s84
  s_lshl_b32 s45, s84, 4
  s_sub_u32 s45, 16384, s45
  v_sub_u32 v15, s44, v233
  v_ashrrev_i32 v15, 31, v15
  v_and_b32 v15, s45, v15
  v_add_u32 v254, v254, v15
  s_add_u32 s44, s44, s85
  s_lshl_b32 s45, s85, 4
  s_sub_u32 s45, 16384, s45
  v_sub_u32 v15, s44, v233
  v_ashrrev_i32 v15, 31, v15
  v_and_b32 v15, s45, v15
  v_add_u32 v254, v254, v15
  s_add_u32 s44, s44, s86
  s_lshl_b32 s45, s86, 4
  s_sub_u32 s45, 16384, s45
  v_sub_u32 v15, s44, v233
  v_ashrrev_i32 v15, 31, v15
  v_and_b32 v15, s45, v15
  v_add_u32 v254, v254, v15
  s_add_u32 s44, s44, s87
  s_lshl_b32 s45, s87, 4
  s_sub_u32 s45, 16384, s45
  v_sub_u32 v15, s44, v233
  v_ashrrev_i32 v15, 31, v15
  v_and_b32 v15, s45, v15
  v_add_u32 v254, v254, v15
  s_add_u32 s44, s44, s88
  s_lshl_b32 s45, s88, 4
  s_sub_u32 s45, 16384, s45
  v_sub_u32 v15, s44, v233
  v_ashrrev_i32 v15, 31, v15
  v_and_b32 v15, s45, v15
  v_add_u32 v254, v254, v15
  s_add_u32 s44, s44, s89
  s_lshl_b32 s45, s89, 4
  s_sub_u32 s45, 16384, s45
  v_sub_u32 v15, s44, v233
  v_ashrrev_i32 v15, 31, v15
  v_and_b32 v15, s45, v15
  v_add_u32 v254, v254, v15
  s_add_u32 s44, s44, s90
  s_lshl_b32 s45, s90, 4
  s_sub_u32 s45, 16384, s45
  v_sub_u32 v15, s44, v233
  v_ashrrev_i32 v15, 31, v15
  v_and_b32 v15, s45, v15
  v_add_u32 v254, v254, v15
  s_add_u32 s44, s44, s91
  s_lshl_b32 s45, s91, 4
  s_sub_u32 s45, 16384, s45
  v_sub_u32 v15, s44, v233
  v_ashrrev_i32 v15, 31, v15
  v_and_b32 v15, s45, v15
  v_add_u32 v254, v254, v15
  s_add_u32 s44, s44, s92
  s_lshl_b32 s45, s92, 4
  s_sub_u32 s45, 16384, s45
  v_sub_u32 v15, s44, v233
  v_ashrrev_i32 v15, 31, v15
  v_and_b32 v15, s45, v15
  v_add_u32 v254, v254, v15
  s_add_u32 s44, s44, s93
  s_lshl_b32 s45, s93, 4
  s_sub_u32 s45, 16384, s45
  v_sub_u32 v15, s44, v233
  v_ashrrev_i32 v15, 31, v15
  v_and_b32 v15, s45, v15
  v_add_u32 v254, v254, v15
  s_add_u32 s44, s44, s94
  s_lshl_b32 s45, s94, 4
  s_sub_u32 s45, 16384, s45
  v_sub_u32 v15, s44, v233
  v_ashrrev_i32 v15, 31, v15
  v_and_b32 v15, s45, v15
  v_add_u32 v254, v254, v15
  s_add_u32 s44, s44, s95
  v_sub_u32 v15, s44, v233
  v_ashrrev_i32 v15, 31, v15
  v_and_b32 v15, 1073741824, v15
  v_or_b32 v254, v254, v15
  s_add_u32 s39, s44, 16
  s_lshr_b32 s39, s39, 4
  s_lshl_b32 s51, s33, 18
  s_add_u32 s51, s51, 2097152
  ds_bpermute_b32 v128, v252, v254 offset:0
  ds_bpermute_b32 v132, v235, v254 offset:0
  ds_bpermute_b32 v129, v252, v254 offset:4
  ds_bpermute_b32 v133, v235, v254 offset:4
  ds_bpermute_b32 v130, v252, v254 offset:8
  ds_bpermute_b32 v134, v235, v254 offset:16
  ds_bpermute_b32 v131, v252, v254 offset:12
  ds_bpermute_b32 v135, v235, v254 offset:20
  ds_bpermute_b32 v136, v252, v254 offset:64
  ds_bpermute_b32 v140, v235, v254 offset:64
  ds_bpermute_b32 v137, v252, v254 offset:68
  ds_bpermute_b32 v141, v235, v254 offset:68
  ds_bpermute_b32 v138, v252, v254 offset:72
  ds_bpermute_b32 v142, v235, v254 offset:80
  ds_bpermute_b32 v139, v252, v254 offset:76
  ds_bpermute_b32 v143, v235, v254 offset:84
  ds_bpermute_b32 v144, v252, v254 offset:128
  ds_bpermute_b32 v148, v235, v254 offset:128
  ds_bpermute_b32 v145, v252, v254 offset:132
  ds_bpermute_b32 v149, v235, v254 offset:132
  ds_bpermute_b32 v146, v252, v254 offset:136
  ds_bpermute_b32 v150, v235, v254 offset:144
  ds_bpermute_b32 v147, v252, v254 offset:140
  ds_bpermute_b32 v151, v235, v254 offset:148
  ds_bpermute_b32 v152, v252, v254 offset:192
  ds_bpermute_b32 v156, v235, v254 offset:192
  ds_bpermute_b32 v153, v252, v254 offset:196
  ds_bpermute_b32 v157, v235, v254 offset:196
  ds_bpermute_b32 v154, v252, v254 offset:200
  ds_bpermute_b32 v158, v235, v254 offset:208
  ds_bpermute_b32 v155, v252, v254 offset:204
  ds_bpermute_b32 v159, v235, v254 offset:212
  s_waitcnt lgkmcnt(0)
  buffer_load_dwordx2 v[192:193], v128, s[24:27], s51 offen
  buffer_load_dwordx2 v[96:97], v132, s[24:27], s51 offen offset:8
  buffer_load_dwordx2 v[194:195], v129, s[24:27], s51 offen
  buffer_load_dwordx2 v[98:99], v133, s[24:27], s51 offen offset:8
  buffer_load_dwordx2 v[196:197], v130, s[24:27], s51 offen
  buffer_load_dwordx2 v[100:101], v134, s[24:27], s51 offen offset:8
  buffer_load_dwordx2 v[198:199], v131, s[24:27], s51 offen
  buffer_load_dwordx2 v[102:103], v135, s[24:27], s51 offen offset:8
  buffer_load_dwordx2 v[200:201], v136, s[24:27], s51 offen
  buffer_load_dwordx2 v[104:105], v140, s[24:27], s51 offen offset:8
  buffer_load_dwordx2 v[202:203], v137, s[24:27], s51 offen
  buffer_load_dwordx2 v[106:107], v141, s[24:27], s51 offen offset:8
  buffer_load_dwordx2 v[204:205], v138, s[24:27], s51 offen
  buffer_load_dwordx2 v[108:109], v142, s[24:27], s51 offen offset:8
  buffer_load_dwordx2 v[206:207], v139, s[24:27], s51 offen
  buffer_load_dwordx2 v[110:111], v143, s[24:27], s51 offen offset:8
  buffer_load_dwordx2 v[208:209], v144, s[24:27], s51 offen
  buffer_load_dwordx2 v[112:113], v148, s[24:27], s51 offen offset:8
  buffer_load_dwordx2 v[210:211], v145, s[24:27], s51 offen
  buffer_load_dwordx2 v[114:115], v149, s[24:27], s51 offen offset:8
  buffer_load_dwordx2 v[212:213], v146, s[24:27], s51 offen
  buffer_load_dwordx2 v[116:117], v150, s[24:27], s51 offen offset:8
  buffer_load_dwordx2 v[214:215], v147, s[24:27], s51 offen
  buffer_load_dwordx2 v[118:119], v151, s[24:27], s51 offen offset:8
  buffer_load_dwordx2 v[216:217], v152, s[24:27], s51 offen
  buffer_load_dwordx2 v[120:121], v156, s[24:27], s51 offen offset:8
  buffer_load_dwordx2 v[218:219], v153, s[24:27], s51 offen
  buffer_load_dwordx2 v[122:123], v157, s[24:27], s51 offen offset:8
  buffer_load_dwordx2 v[220:221], v154, s[24:27], s51 offen
  buffer_load_dwordx2 v[124:125], v158, s[24:27], s51 offen offset:8
  buffer_load_dwordx2 v[222:223], v155, s[24:27], s51 offen
  buffer_load_dwordx2 v[126:127], v159, s[24:27], s51 offen offset:8
  buffer_load_dwordx4 a[48:51], v255, s[24:27], s66 offen offset:0
  buffer_load_dwordx4 a[52:55], v255, s[24:27], s66 offen offset:1024
  buffer_load_dwordx4 a[56:59], v255, s[24:27], s66 offen offset:2048
  buffer_load_dwordx4 a[60:63], v255, s[24:27], s66 offen offset:3072
  s_add_u32 s66, s66, 4096
  buffer_load_dwordx4 a[64:67], v255, s[24:27], s66 offen offset:0
  buffer_load_dwordx4 a[68:71], v255, s[24:27], s66 offen offset:1024
  buffer_load_dwordx4 a[72:75], v255, s[24:27], s66 offen offset:2048
  buffer_load_dwordx4 a[76:79], v255, s[24:27], s66 offen offset:3072
  s_add_u32 s66, s66, 4096
  buffer_load_dwordx4 a[80:83], v255, s[24:27], s66 offen offset:0
  buffer_load_dwordx4 a[84:87], v255, s[24:27], s66 offen offset:1024
  buffer_load_dwordx4 a[88:91], v255, s[24:27], s66 offen offset:2048
  buffer_load_dwordx4 a[92:95], v255, s[24:27], s66 offen offset:3072
  s_add_u32 s66, s66, 4096
  s_add_u32 m0, s60, 2048
  s_nop 0
  buffer_load_dwordx4 v3, s[16:19], s36 offen offset:0 nt lds
  buffer_load_dwordx4 v3, s[16:19], s36 offen offset:1024 nt lds
  s_add_u32 m0, s61, 2048
  s_nop 0
  buffer_load_dwordx4 v4, s[16:19], s36 offen offset:0 nt lds
  buffer_load_dwordx4 v4, s[16:19], s36 offen offset:1024 nt lds
  s_add_u32 m0, s62, 2048
  s_nop 0
  buffer_load_dwordx4 v5, s[16:19], s36 offen offset:0 nt lds
  buffer_load_dwordx4 v5, s[16:19], s36 offen offset:1024 nt lds
  s_add_u32 m0, s63, 2048
  s_nop 0
  buffer_load_dwordx4 v6, s[16:19], s36 offen offset:0 nt lds
  buffer_load_dwordx4 v6, s[16:19], s36 offen offset:1024 nt lds
  s_add_u32 s59, s59, 1
  s_add_u32 s40, s40, 32768
  s_and_b32 s40, s40, 0x7ffff
  s_add_u32 s36, s40, s56
  s_cmp_ge_u32 s59, 16
  s_cselect_b32 s36, 1073741824, s36
  s_waitcnt vmcnt(63)
  v_lshlrev_b32 v48, 16, v224
  v_and_b32 v49, 0xffff0000, v224
  v_lshlrev_b32 v50, 16, v225
  v_and_b32 v51, 0xffff0000, v225
  v_lshlrev_b32 v52, 16, v226
  v_and_b32 v53, 0xffff0000, v226
  v_lshlrev_b32 v54, 16, v227
  v_and_b32 v55, 0xffff0000, v227
  v_lshlrev_b32 v56, 16, v228
  v_and_b32 v57, 0xffff0000, v228
  v_lshlrev_b32 v58, 16, v229
  v_and_b32 v59, 0xffff0000, v229
  v_lshlrev_b32 v60, 16, v230
  v_and_b32 v61, 0xffff0000, v230
  v_lshlrev_b32 v62, 16, v231
  v_and_b32 v63, 0xffff0000, v231
  s_waitcnt vmcnt(44)
  v_xor_b32 v192, v192, v12
  v_xor_b32 v193, v193, v12
  v_xor_b32 v194, v194, v12
  v_xor_b32 v195, v195, v12
  v_xor_b32 v196, v196, v12
  v_xor_b32 v197, v197, v12
  v_xor_b32 v198, v198, v12
  v_xor_b32 v199, v199, v12
  v_xor_b32 v97, v97, v0
  v_xor_b32 v99, v99, v0
  v_xor_b32 v101, v101, v0
  v_xor_b32 v103, v103, v0
  v_pk_min_u16 v128, v97, s64
  v_pk_add_u16 v128, v128, s65
  v_and_b32 v128, v128, v96
  v_pk_min_u16 v129, v99, s64
  v_pk_add_u16 v129, v129, s65
  v_and_b32 v129, v129, v98
  v_pk_min_u16 v130, v101, s64
  v_pk_add_u16 v130, v130, s65
  v_and_b32 v130, v130, v100
  v_pk_min_u16 v131, v103, s64
  v_pk_add_u16 v131, v131, s65
  v_and_b32 v131, v131, v102
  v_xor_b32 v132, 262148, v97
  v_pk_min_u16 v132, v132, s64
  v_pk_add_u16 v132, v132, s65
  v_and_b32 v132, v132, v96
  v_xor_b32 v133, 262148, v99
  v_pk_min_u16 v133, v133, s64
  v_pk_add_u16 v133, v133, s65
  v_and_b32 v133, v133, v98
  v_xor_b32 v134, 262148, v101
  v_pk_min_u16 v134, v134, s64
  v_pk_add_u16 v134, v134, s65
  v_and_b32 v134, v134, v100
  v_xor_b32 v135, 262148, v103
  v_pk_min_u16 v135, v135, s64
  v_pk_add_u16 v135, v135, s65
  v_and_b32 v135, v135, v102
  v_xor_b32 v136, 2097184, v97
  v_pk_min_u16 v136, v136, s64
  v_pk_add_u16 v136, v136, s65
  v_and_b32 v136, v136, v96
  v_xor_b32 v137, 2097184, v99
  v_pk_min_u16 v137, v137, s64
  v_pk_add_u16 v137, v137, s65
  v_and_b32 v137, v137, v98
  v_xor_b32 v138, 2097184, v101
  v_pk_min_u16 v138, v138, s64
  v_pk_add_u16 v138, v138, s65
  v_and_b32 v138, v138, v100
  v_xor_b32 v139, 2097184, v103
  v_pk_min_u16 v139, v139, s64
  v_pk_add_u16 v139, v139, s65
  v_and_b32 v139, v139, v102
  v_xor_b32 v140, 2359332, v97
  v_pk_min_u16 v140, v140, s64
  v_pk_add_u16 v140, v140, s65
  v_and_b32 v140, v140, v96
  v_xor_b32 v141, 2359332, v99
  v_pk_min_u16 v141, v141, s64
  v_pk_add_u16 v141, v141, s65
  v_and_b32 v141, v141, v98
  v_xor_b32 v142, 2359332, v101
  v_pk_min_u16 v142, v142, s64
  v_pk_add_u16 v142, v142, s65
  v_and_b32 v142, v142, v100
  v_xor_b32 v143, 2359332, v103
  v_pk_min_u16 v143, v143, s64
  v_pk_add_u16 v143, v143, s65
  v_and_b32 v143, v143, v102
  s_waitcnt vmcnt(36)
  v_xor_b32 v200, v200, v12
  v_xor_b32 v201, v201, v12
  v_xor_b32 v202, v202, v12
  v_xor_b32 v203, v203, v12
  v_xor_b32 v204, v204, v12
  v_xor_b32 v205, v205, v12
  v_xor_b32 v206, v206, v12
  v_xor_b32 v207, v207, v12
  v_xor_b32 v105, v105, v0
  v_xor_b32 v107, v107, v0
  v_xor_b32 v109, v109, v0
  v_xor_b32 v111, v111, v0
  v_pk_min_u16 v144, v105, s64
  v_pk_add_u16 v144, v144, s65
  v_and_b32 v144, v144, v104
  v_pk_min_u16 v145, v107, s64
  v_pk_add_u16 v145, v145, s65
  v_and_b32 v145, v145, v106
  v_pk_min_u16 v146, v109, s64
  v_pk_add_u16 v146, v146, s65
  v_and_b32 v146, v146, v108
  v_pk_min_u16 v147, v111, s64
  v_pk_add_u16 v147, v147, s65
  v_and_b32 v147, v147, v110
  v_xor_b32 v148, 262148, v105
  v_pk_min_u16 v148, v148, s64
  v_pk_add_u16 v148, v148, s65
  v_and_b32 v148, v148, v104
  v_xor_b32 v149, 262148, v107
  v_pk_min_u16 v149, v149, s64
  v_pk_add_u16 v149, v149, s65
  v_and_b32 v149, v149, v106
  v_xor_b32 v150, 262148, v109
  v_pk_min_u16 v150, v150, s64
  v_pk_add_u16 v150, v150, s65
  v_and_b32 v150, v150, v108
  v_xor_b32 v151, 262148, v111
  v_pk_min_u16 v151, v151, s64
  v_pk_add_u16 v151, v151, s65
  v_and_b32 v151, v151, v110
  v_xor_b32 v152, 2097184, v105
  v_pk_min_u16 v152, v152, s64
  v_pk_add_u16 v152, v152, s65
  v_and_b32 v152, v152, v104
  v_xor_b32 v153, 2097184, v107
  v_pk_min_u16 v153, v153, s64
  v_pk_add_u16 v153, v153, s65
  v_and_b32 v153, v153, v106
  v_xor_b32 v154, 2097184, v109
  v_pk_min_u16 v154, v154, s64
  v_pk_add_u16 v154, v154, s65
  v_and_b32 v154, v154, v108
  v_xor_b32 v155, 2097184, v111
  v_pk_min_u16 v155, v155, s64
  v_pk_add_u16 v155, v155, s65
  v_and_b32 v155, v155, v110
  v_xor_b32 v156, 2359332, v105
  v_pk_min_u16 v156, v156, s64
  v_pk_add_u16 v156, v156, s65
  v_and_b32 v156, v156, v104
  v_xor_b32 v157, 2359332, v107
  v_pk_min_u16 v157, v157, s64
  v_pk_add_u16 v157, v157, s65
  v_and_b32 v157, v157, v106
  v_xor_b32 v158, 2359332, v109
  v_pk_min_u16 v158, v158, s64
  v_pk_add_u16 v158, v158, s65
  v_and_b32 v158, v158, v108
  v_xor_b32 v159, 2359332, v111
  v_pk_min_u16 v159, v159, s64
  v_pk_add_u16 v159, v159, s65
  v_and_b32 v159, v159, v110
  s_waitcnt vmcnt(28)
  v_xor_b32 v208, v208, v12
  v_xor_b32 v209, v209, v12
  v_xor_b32 v210, v210, v12
  v_xor_b32 v211, v211, v12
  v_xor_b32 v212, v212, v12
  v_xor_b32 v213, v213, v12
  v_xor_b32 v214, v214, v12
  v_xor_b32 v215, v215, v12
  v_xor_b32 v113, v113, v0
  v_xor_b32 v115, v115, v0
  v_xor_b32 v117, v117, v0
  v_xor_b32 v119, v119, v0
  v_pk_min_u16 v160, v113, s64
  v_pk_add_u16 v160, v160, s65
  v_and_b32 v160, v160, v112
  v_pk_min_u16 v161, v115, s64
  v_pk_add_u16 v161, v161, s65
  v_and_b32 v161, v161, v114
  v_pk_min_u16 v162, v117, s64
  v_pk_add_u16 v162, v162, s65
  v_and_b32 v162, v162, v116
  v_pk_min_u16 v163, v119, s64
  v_pk_add_u16 v163, v163, s65
  v_and_b32 v163, v163, v118
  v_xor_b32 v164, 262148, v113
  v_pk_min_u16 v164, v164, s64
  v_pk_add_u16 v164, v164, s65
  v_and_b32 v164, v164, v112
  v_xor_b32 v165, 262148, v115
  v_pk_min_u16 v165, v165, s64
  v_pk_add_u16 v165, v165, s65
  v_and_b32 v165, v165, v114
  v_xor_b32 v166, 262148, v117
  v_pk_min_u16 v166, v166, s64
  v_pk_add_u16 v166, v166, s65
  v_and_b32 v166, v166, v116
  v_xor_b32 v167, 262148, v119
  v_pk_min_u16 v167, v167, s64
  v_pk_add_u16 v167, v167, s65
  v_and_b32 v167, v167, v118
  v_xor_b32 v168, 2097184, v113
  v_pk_min_u16 v168, v168, s64
  v_pk_add_u16 v168, v168, s65
  v_and_b32 v168, v168, v112
  v_xor_b32 v169, 2097184, v115
  v_pk_min_u16 v169, v169, s64
  v_pk_add_u16 v169, v169, s65
  v_and_b32 v169, v169, v114
  v_xor_b32 v170, 2097184, v117
  v_pk_min_u16 v170, v170, s64
  v_pk_add_u16 v170, v170, s65
  v_and_b32 v170, v170, v116
  v_xor_b32 v171, 2097184, v119
  v_pk_min_u16 v171, v171, s64
  v_pk_add_u16 v171, v171, s65
  v_and_b32 v171, v171, v118
  v_xor_b32 v172, 2359332, v113
  v_pk_min_u16 v172, v172, s64
  v_pk_add_u16 v172, v172, s65
  v_and_b32 v172, v172, v112
  v_xor_b32 v173, 2359332, v115
  v_pk_min_u16 v173, v173, s64
  v_pk_add_u16 v173, v173, s65
  v_and_b32 v173, v173, v114
  v_xor_b32 v174, 2359332, v117
  v_pk_min_u16 v174, v174, s64
  v_pk_add_u16 v174, v174, s65
  v_and_b32 v174, v174, v116
  v_xor_b32 v175, 2359332, v119
  v_pk_min_u16 v175, v175, s64
  v_pk_add_u16 v175, v175, s65
  v_and_b32 v175, v175, v118
  s_waitcnt vmcnt(20)
  v_xor_b32 v216, v216, v12
  v_xor_b32 v217, v217, v12
  v_xor_b32 v218, v218, v12
  v_xor_b32 v219, v219, v12
  v_xor_b32 v220, v220, v12
  v_xor_b32 v221, v221, v12
  v_xor_b32 v222, v222, v12
  v_xor_b32 v223, v223, v12
  v_xor_b32 v121, v121, v0
  v_xor_b32 v123, v123, v0
  v_xor_b32 v125, v125, v0
  v_xor_b32 v127, v127, v0
  v_pk_min_u16 v176, v121, s64
  v_pk_add_u16 v176, v176, s65
  v_and_b32 v176, v176, v120
  v_pk_min_u16 v177, v123, s64
  v_pk_add_u16 v177, v177, s65
  v_and_b32 v177, v177, v122
  v_pk_min_u16 v178, v125, s64
  v_pk_add_u16 v178, v178, s65
  v_and_b32 v178, v178, v124
  v_pk_min_u16 v179, v127, s64
  v_pk_add_u16 v179, v179, s65
  v_and_b32 v179, v179, v126
  v_xor_b32 v180, 262148, v121
  v_pk_min_u16 v180, v180, s64
  v_pk_add_u16 v180, v180, s65
  v_and_b32 v180, v180, v120
  v_xor_b32 v181, 262148, v123
  v_pk_min_u16 v181, v181, s64
  v_pk_add_u16 v181, v181, s65
  v_and_b32 v181, v181, v122
  v_xor_b32 v182, 262148, v125
  v_pk_min_u16 v182, v182, s64
  v_pk_add_u16 v182, v182, s65
  v_and_b32 v182, v182, v124
  v_xor_b32 v183, 262148, v127
  v_pk_min_u16 v183, v183, s64
  v_pk_add_u16 v183, v183, s65
  v_and_b32 v183, v183, v126
  v_xor_b32 v184, 2097184, v121
  v_pk_min_u16 v184, v184, s64
  v_pk_add_u16 v184, v184, s65
  v_and_b32 v184, v184, v120
  v_xor_b32 v185, 2097184, v123
  v_pk_min_u16 v185, v185, s64
  v_pk_add_u16 v185, v185, s65
  v_and_b32 v185, v185, v122
  v_xor_b32 v186, 2097184, v125
  v_pk_min_u16 v186, v186, s64
  v_pk_add_u16 v186, v186, s65
  v_and_b32 v186, v186, v124
  v_xor_b32 v187, 2097184, v127
  v_pk_min_u16 v187, v187, s64
  v_pk_add_u16 v187, v187, s65
  v_and_b32 v187, v187, v126
  v_xor_b32 v188, 2359332, v121
  v_pk_min_u16 v188, v188, s64
  v_pk_add_u16 v188, v188, s65
  v_and_b32 v188, v188, v120
  v_xor_b32 v189, 2359332, v123
  v_pk_min_u16 v189, v189, s64
  v_pk_add_u16 v189, v189, s65
  v_and_b32 v189, v189, v122
  v_xor_b32 v190, 2359332, v125
  v_pk_min_u16 v190, v190, s64
  v_pk_add_u16 v190, v190, s65
  v_and_b32 v190, v190, v124
  v_xor_b32 v191, 2359332, v127
  v_pk_min_u16 v191, v191, s64
  v_pk_add_u16 v191, v191, s65
  v_and_b32 v191, v191, v126
  v_mov_b32 v64, v48
  v_mov_b32 v65, v49
  v_mov_b32 v66, v50
  v_mov_b32 v67, v51
  v_mov_b32 v68, v52
  v_mov_b32 v69, v53
  v_mov_b32 v70, v54
  v_mov_b32 v71, v55
  v_mov_b32 v72, v56
  v_mov_b32 v73, v57
  v_mov_b32 v74, v58
  v_mov_b32 v75, v59
  v_mov_b32 v76, v60
  v_mov_b32 v77, v61
  v_mov_b32 v78, v62
  v_mov_b32 v79, v63
  v_mov_b32 v80, v48
  v_mov_b32 v81, v49
  v_mov_b32 v82, v50
  v_mov_b32 v83, v51
  v_mov_b32 v84, v52
  v_mov_b32 v85, v53
  v_mov_b32 v86, v54
  v_mov_b32 v87, v55
  v_mov_b32 v88, v56
  v_mov_b32 v89, v57
  v_mov_b32 v90, v58
  v_mov_b32 v91, v59
  v_mov_b32 v92, v60
  v_mov_b32 v93, v61
  v_mov_b32 v94, v62
  v_mov_b32 v95, v63
  s_waitcnt vmcnt(63)
  s_barrier
  s_lshl_b32 s42, s33, 7
  s_add_u32 s42, s42, s56
  s_add_u32 s37, s42, s41
  s_mov_b32 s38, 0
  ds_read_b128 v[96:99], v8 offset:0
  ds_read_b128 v[100:103], v9 offset:0
  ds_read_b128 v[104:107], v10 offset:0
  ds_read_b128 v[108:111], v11 offset:0
  ds_read_b128 v[112:115], v8 offset:256
  ds_read_b128 v[116:119], v9 offset:256
  s_waitcnt vmcnt(60) lgkmcnt(4)
  v_smfmac_f32_16x16x64_bf16 v[64:67], a[0:3], v[96:103], v16
  ds_read_b128 v[120:123], v10 offset:256
  ds_read_b128 v[124:127], v11 offset:256
  buffer_load_dwordx4 a[96:99], v255, s[24:27], s66 offen offset:0
  v_smfmac_f32_16x16x64_bf16 v[68:71], a[4:7], v[96:103], v24
  buffer_load_dwordx4 a[100:103], v255, s[24:27], s66 offen offset:1024
  buffer_load_dwordx4 a[104:107], v255, s[24:27], s66 offen offset:2048
  buffer_load_dwordx4 a[108:111], v255, s[24:27], s66 offen offset:3072
  v_smfmac_f32_16x16x64_bf16 v[72:75], a[8:11], v[96:103], v32
  s_add_u32 s66, s66, 4096
  ds_read_u16 v224, v192 offset:0
  ds_read_u16 v225, v193 offset:0
  v_smfmac_f32_16x16x64_bf16 v[76:79], a[12:15], v[96:103], v40
  ds_read_u16 v226, v194 offset:0
  ds_read_u16 v227, v195 offset:0
  s_waitcnt vmcnt(60) lgkmcnt(8)
  v_smfmac_f32_16x16x64_bf16 v[64:67], a[16:19], v[104:111], v16 abid:1
  ds_read_b128 v[96:99], v8 offset:512
  ds_read_b128 v[100:103], v9 offset:512
  buffer_load_dwordx4 a[112:115], v255, s[24:27], s66 offen offset:0
  v_smfmac_f32_16x16x64_bf16 v[68:71], a[20:23], v[104:111], v24 abid:1
  buffer_load_dwordx4 a[116:119], v255, s[24:27], s66 offen offset:1024
  buffer_load_dwordx4 a[120:123], v255, s[24:27], s66 offen offset:2048
  buffer_load_dwordx4 a[124:127], v255, s[24:27], s66 offen offset:3072
  v_smfmac_f32_16x16x64_bf16 v[72:75], a[24:27], v[104:111], v32 abid:1
  s_add_u32 s66, s66, 4096
  ds_read_u16 v228, v196 offset:0
  ds_read_u16 v229, v197 offset:0
  v_smfmac_f32_16x16x64_bf16 v[76:79], a[28:31], v[104:111], v40 abid:1
  ds_read_u16 v230, v198 offset:0
  ds_read_u16 v231, v199 offset:0
  s_waitcnt vmcnt(60) lgkmcnt(12)
  v_smfmac_f32_16x16x64_bf16 v[64:67], a[32:35], v[112:119], v17
  ds_read_b128 v[104:107], v10 offset:512
  ds_read_b128 v[108:111], v11 offset:512
  v_smfmac_f32_16x16x64_bf16 v[68:71], a[36:39], v[112:119], v25
  buffer_load_dwordx4 a[128:131], v255, s[24:27], s66 offen offset:0
  buffer_load_dwordx4 a[132:135], v255, s[24:27], s66 offen offset:1024
  v_smfmac_f32_16x16x64_bf16 v[72:75], a[40:43], v[112:119], v33
  buffer_load_dwordx4 a[136:139], v255, s[24:27], s66 offen offset:2048
  buffer_load_dwordx4 a[140:143], v255, s[24:27], s66 offen offset:3072
  v_smfmac_f32_16x16x64_bf16 v[76:79], a[44:47], v[112:119], v41
  s_add_u32 s66, s66, 4096
  s_waitcnt vmcnt(28) lgkmcnt(12)
  v_smfmac_f32_16x16x64_bf16 v[64:67], a[48:51], v[120:127], v17 abid:1
  s_waitcnt lgkmcnt(2)
  v_lshl_or_b32 v224, v225, 16, v224
  v_lshl_or_b32 v226, v227, 16, v226
  v_lshl_or_b32 v228, v229, 16, v228
  v_smfmac_f32_16x16x64_bf16 v[68:71], a[52:55], v[120:127], v25 abid:1
  v_lshl_or_b32 v230, v231, 16, v230
  ds_read_b128 v[112:115], v8 offset:768
  ds_read_b128 v[116:119], v9 offset:768
  buffer_load_dwordx4 a[144:147], v255, s[24:27], s66 offen offset:0
  v_smfmac_f32_16x16x64_bf16 v[72:75], a[56:59], v[120:127], v33 abid:1
  buffer_load_dwordx4 a[148:151], v255, s[24:27], s66 offen offset:1024
  buffer_load_dwordx4 a[152:155], v255, s[24:27], s66 offen offset:2048
  buffer_load_dwordx4 a[156:159], v255, s[24:27], s66 offen offset:3072
  s_add_u32 s66, s66, 4096
  v_smfmac_f32_16x16x64_bf16 v[76:79], a[60:63], v[120:127], v41 abid:1
  ds_read_u16 v244, v200 offset:0
  ds_read_u16 v245, v201 offset:0
  ds_read_u16 v246, v202 offset:0
  ds_read_u16 v247, v203 offset:0
  v_smfmac_f32_16x16x64_bf16 v[64:67], v[128:131], v[224:231], v253
  v_smfmac_f32_16x16x64_bf16 v[68:71], v[132:135], v[224:231], v253
  v_smfmac_f32_16x16x64_bf16 v[72:75], v[136:139], v[224:231], v253
  v_smfmac_f32_16x16x64_bf16 v[76:79], v[140:143], v[224:231], v253
  s_waitcnt vmcnt(28) lgkmcnt(12)
  v_smfmac_f32_16x16x64_bf16 v[64:67], a[64:67], v[96:103], v18
  ds_read_b128 v[120:123], v10 offset:768
  ds_read_b128 v[124:127], v11 offset:768
  buffer_load_dwordx4 a[160:163], v255, s[24:27], s66 offen offset:0
  buffer_load_dwordx4 a[164:167], v255, s[24:27], s66 offen offset:1024
  v_smfmac_f32_16x16x64_bf16 v[68:71], a[68:71], v[96:103], v26
  buffer_load_dwordx4 a[168:171], v255, s[24:27], s66 offen offset:2048
  buffer_load_dwordx4 a[172:175], v255, s[24:27], s66 offen offset:3072
  s_add_u32 s66, s66, 4096
  s_add_u32 m0, s60, 4096
  v_smfmac_f32_16x16x64_bf16 v[72:75], a[72:75], v[96:103], v34
  s_nop 0
  buffer_load_dwordx4 v3, s[16:19], s36 offen offset:0 nt lds
  buffer_load_dwordx4 v3, s[16:19], s36 offen offset:1024 nt lds
  ds_read_u16 v248, v204 offset:0
  v_smfmac_f32_16x16x64_bf16 v[76:79], a[76:79], v[96:103], v42
  ds_read_u16 v249, v205 offset:0
  ds_read_u16 v250, v206 offset:0
  ds_read_u16 v251, v207 offset:0
  s_waitcnt vmcnt(30) lgkmcnt(12)
  v_smfmac_f32_16x16x64_bf16 v[64:67], a[80:83], v[104:111], v18 abid:1
  ds_read_b128 v[96:99], v8 offset:1024
  ds_read_b128 v[100:103], v9 offset:1024
  buffer_load_dwordx4 a[176:179], v255, s[24:27], s66 offen offset:0
  v_smfmac_f32_16x16x64_bf16 v[68:71], a[84:87], v[104:111], v26 abid:1
  buffer_load_dwordx4 a[180:183], v255, s[24:27], s66 offen offset:1024
  buffer_load_dwordx4 a[184:187], v255, s[24:27], s66 offen offset:2048
  buffer_load_dwordx4 a[188:191], v255, s[24:27], s66 offen offset:3072
  v_smfmac_f32_16x16x64_bf16 v[72:75], a[88:91], v[104:111], v34 abid:1
  s_add_u32 s66, s66, 4096
  s_add_u32 m0, s61, 4096
  s_nop 0
  v_smfmac_f32_16x16x64_bf16 v[76:79], a[92:95], v[104:111], v42 abid:1
  buffer_load_dwordx4 v4, s[16:19], s36 offen offset:0 nt lds
  buffer_load_dwordx4 v4, s[16:19], s36 offen offset:1024 nt lds
  s_waitcnt vmcnt(24) lgkmcnt(12)
  v_smfmac_f32_16x16x64_bf16 v[64:67], a[96:99], v[112:119], v19
  s_waitcnt lgkmcnt(2)
  v_lshl_or_b32 v244, v245, 16, v244
  v_lshl_or_b32 v246, v247, 16, v246
  v_lshl_or_b32 v248, v249, 16, v248
  v_lshl_or_b32 v250, v251, 16, v250
  v_smfmac_f32_16x16x64_bf16 v[68:71], a[100:103], v[112:119], v27
  ds_read_b128 v[104:107], v10 offset:1024
  ds_read_b128 v[108:111], v11 offset:1024
  buffer_load_dwordx4 a[192:195], v255, s[24:27], s66 offen offset:0
  buffer_load_dwordx4 a[196:199], v255, s[24:27], s66 offen offset:1024
  buffer_load_dwordx4 a[200:203], v255, s[24:27], s66 offen offset:2048
  v_smfmac_f32_16x16x64_bf16 v[72:75], a[104:107], v[112:119], v35
  buffer_load_dwordx4 a[204:207], v255, s[24:27], s66 offen offset:3072
  s_add_u32 s66, s66, 4096
  s_add_u32 m0, s62, 4096
  s_nop 0
  buffer_load_dwordx4 v5, s[16:19], s36 offen offset:0 nt lds
  v_smfmac_f32_16x16x64_bf16 v[76:79], a[108:111], v[112:119], v43
  buffer_load_dwordx4 v5, s[16:19], s36 offen offset:1024 nt lds
  ds_read_u16 v224, v208 offset:0
  ds_read_u16 v225, v209 offset:0
  ds_read_u16 v226, v210 offset:0
  ds_read_u16 v227, v211 offset:0
  v_smfmac_f32_16x16x64_bf16 v[64:67], v[144:147], v[244:251], v253
  v_smfmac_f32_16x16x64_bf16 v[68:71], v[148:151], v[244:251], v253
  v_smfmac_f32_16x16x64_bf16 v[72:75], v[152:155], v[244:251], v253
  v_smfmac_f32_16x16x64_bf16 v[76:79], v[156:159], v[244:251], v253
  s_waitcnt vmcnt(26) lgkmcnt(12)
  v_smfmac_f32_16x16x64_bf16 v[64:67], a[112:115], v[120:127], v19 abid:1
  ds_read_b128 v[112:115], v8 offset:1280
  ds_read_b128 v[116:119], v9 offset:1280
  buffer_load_dwordx4 a[208:211], v255, s[24:27], s66 offen offset:0
  buffer_load_dwordx4 a[212:215], v255, s[24:27], s66 offen offset:1024
  buffer_load_dwordx4 a[216:219], v255, s[24:27], s66 offen offset:2048
  buffer_load_dwordx4 a[220:223], v255, s[24:27], s66 offen offset:3072
  v_smfmac_f32_16x16x64_bf16 v[68:71], a[116:119], v[120:127], v27 abid:1
  s_add_u32 s66, s66, 4096
  s_add_u32 m0, s63, 4096
  s_nop 0
  buffer_load_dwordx4 v6, s[16:19], s36 offen offset:0 nt lds
  buffer_load_dwordx4 v6, s[16:19], s36 offen offset:1024 nt lds
  v_smfmac_f32_16x16x64_bf16 v[72:75], a[120:123], v[120:127], v35 abid:1
  s_add_u32 s59, s59, 1
  s_add_u32 s40, s40, 32768
  s_and_b32 s40, s40, 0x7ffff
  s_add_u32 s36, s40, s56
  s_cmp_ge_u32 s59, 16
  v_smfmac_f32_16x16x64_bf16 v[76:79], a[124:127], v[120:127], v43 abid:1
  s_cselect_b32 s36, 1073741824, s36
  ds_read_u16 v228, v212 offset:0
  ds_read_u16 v229, v213 offset:0
  ds_read_u16 v230, v214 offset:0
  ds_read_u16 v231, v215 offset:0
  s_waitcnt vmcnt(28) lgkmcnt(12)
  v_smfmac_f32_16x16x64_bf16 v[64:67], a[128:131], v[96:103], v20
  ds_read_b128 v[120:123], v10 offset:1280
  ds_read_b128 v[124:127], v11 offset:1280
  buffer_load_dwordx4 a[224:227], v255, s[24:27], s66 offen offset:0
  v_smfmac_f32_16x16x64_bf16 v[68:71], a[132:135], v[96:103], v28
  buffer_load_dwordx4 a[228:231], v255, s[24:27], s66 offen offset:1024
  buffer_load_dwordx4 a[232:235], v255, s[24:27], s66 offen offset:2048
  buffer_load_dwordx4 a[236:239], v255, s[24:27], s66 offen offset:3072
  v_smfmac_f32_16x16x64_bf16 v[72:75], a[136:139], v[96:103], v36
  s_add_u32 s66, s66, 4096
  s_add_u32 m0, s60, 6144
  s_nop 0
  v_smfmac_f32_16x16x64_bf16 v[76:79], a[140:143], v[96:103], v44
  buffer_load_dwordx4 v3, s[16:19], s36 offen offset:0 nt lds
  buffer_load_dwordx4 v3, s[16:19], s36 offen offset:1024 nt lds
  s_waitcnt vmcnt(30) lgkmcnt(12)
  v_smfmac_f32_16x16x64_bf16 v[64:67], a[144:147], v[104:111], v20 abid:1
  s_waitcnt lgkmcnt(2)
  v_lshl_or_b32 v224, v225, 16, v224
  v_lshl_or_b32 v226, v227, 16, v226
  v_lshl_or_b32 v228, v229, 16, v228
  v_lshl_or_b32 v230, v231, 16, v230
  v_smfmac_f32_16x16x64_bf16 v[68:71], a[148:151], v[104:111], v28 abid:1
  ds_read_b128 v[96:99], v8 offset:1536
  ds_read_b128 v[100:103], v9 offset:1536
  buffer_load_dwordx4 a[240:243], v255, s[24:27], s66 offen offset:0
  buffer_load_dwordx4 a[244:247], v255, s[24:27], s66 offen offset:1024
  buffer_load_dwordx4 a[248:251], v255, s[24:27], s66 offen offset:2048
  v_smfmac_f32_16x16x64_bf16 v[72:75], a[152:155], v[104:111], v36 abid:1
  buffer_load_dwordx4 a[252:255], v255, s[24:27], s66 offen offset:3072
  s_add_u32 s66, s66, 4096
  s_add_u32 m0, s61, 6144
  s_nop 0
  buffer_load_dwordx4 v4, s[16:19], s36 offen offset:0 nt lds
  v_smfmac_f32_16x16x64_bf16 v[76:79], a[156:159], v[104:111], v44 abid:1
  buffer_load_dwordx4 v4, s[16:19], s36 offen offset:1024 nt lds
  ds_read_u16 v244, v216 offset:0
  ds_read_u16 v245, v217 offset:0
  ds_read_u16 v246, v218 offset:0
  ds_read_u16 v247, v219 offset:0
  v_smfmac_f32_16x16x64_bf16 v[64:67], v[160:163], v[224:231], v253
  v_smfmac_f32_16x16x64_bf16 v[68:71], v[164:167], v[224:231], v253
  v_smfmac_f32_16x16x64_bf16 v[72:75], v[168:171], v[224:231], v253
  v_smfmac_f32_16x16x64_bf16 v[76:79], v[172:175], v[224:231], v253
  s_waitcnt vmcnt(32) lgkmcnt(12)
  v_smfmac_f32_16x16x64_bf16 v[64:67], a[160:163], v[112:119], v21
  ds_read_b128 v[104:107], v10 offset:1536
  ds_read_b128 v[108:111], v11 offset:1536
  s_add_u32 m0, s62, 6144
  v_smfmac_f32_16x16x64_bf16 v[68:71], a[164:167], v[112:119], v29
  s_nop 0
  buffer_load_dwordx4 v5, s[16:19], s36 offen offset:0 nt lds
  buffer_load_dwordx4 v5, s[16:19], s36 offen offset:1024 nt lds
  v_smfmac_f32_16x16x64_bf16 v[72:75], a[168:171], v[112:119], v37
  ds_read_u16 v248, v220 offset:0
  ds_read_u16 v249, v221 offset:0
  v_smfmac_f32_16x16x64_bf16 v[76:79], a[172:175], v[112:119], v45
  ds_read_u16 v250, v222 offset:0
  ds_read_u16 v251, v223 offset:0
  s_waitcnt vmcnt(28) lgkmcnt(12)
  v_smfmac_f32_16x16x64_bf16 v[64:67], a[176:179], v[120:127], v21 abid:1
  ds_read_b128 v[112:115], v8 offset:1792
  ds_read_b128 v[116:119], v9 offset:1792
  s_add_u32 m0, s63, 6144
  v_smfmac_f32_16x16x64_bf16 v[68:71], a[180:183], v[120:127], v29 abid:1
  s_nop 0
  buffer_load_dwordx4 v6, s[16:19], s36 offen offset:0 nt lds
  buffer_load_dwordx4 v6, s[16:19], s36 offen offset:1024 nt lds
  v_smfmac_f32_16x16x64_bf16 v[72:75], a[184:187], v[120:127], v37 abid:1
  s_add_u32 s59, s59, 1
  s_add_u32 s40, s40, 32768
  s_and_b32 s40, s40, 0x7ffff
  v_smfmac_f32_16x16x64_bf16 v[76:79], a[188:191], v[120:127], v45 abid:1
  s_add_u32 s36, s40, s56
  s_cmp_ge_u32 s59, 16
  s_cselect_b32 s36, 1073741824, s36
  s_waitcnt vmcnt(24) lgkmcnt(12)
  v_smfmac_f32_16x16x64_bf16 v[64:67], a[192:195], v[96:103], v22
  s_waitcnt lgkmcnt(2)
  v_lshl_or_b32 v244, v245, 16, v244
  v_smfmac_f32_16x16x64_bf16 v[68:71], a[196:199], v[96:103], v30
  v_lshl_or_b32 v246, v247, 16, v246
  v_lshl_or_b32 v248, v249, 16, v248
  v_smfmac_f32_16x16x64_bf16 v[72:75], a[200:203], v[96:103], v38
  v_lshl_or_b32 v250, v251, 16, v250
  ds_read_b128 v[120:123], v10 offset:1792
  v_smfmac_f32_16x16x64_bf16 v[76:79], a[204:207], v[96:103], v46
  ds_read_b128 v[124:127], v11 offset:1792
  v_smfmac_f32_16x16x64_bf16 v[64:67], v[176:179], v[244:251], v253
  v_smfmac_f32_16x16x64_bf16 v[68:71], v[180:183], v[244:251], v253
  v_smfmac_f32_16x16x64_bf16 v[72:75], v[184:187], v[244:251], v253
  v_smfmac_f32_16x16x64_bf16 v[76:79], v[188:191], v[244:251], v253
  s_cmp_gt_u32 s39, 4
  s_cbranch_scc1 Lslow_f
Lslowback_f:
  s_waitcnt vmcnt(56)
  s_barrier
  s_waitcnt vmcnt(18) lgkmcnt(8)
  v_smfmac_f32_16x16x64_bf16 v[64:67], a[208:211], v[104:111], v22 abid:1
  ds_read_b128 v[96:99], v8 offset:2048
  ds_read_b128 v[100:103], v9 offset:2048
  v_smfmac_f32_16x16x64_bf16 v[68:71], a[212:215], v[104:111], v30 abid:1
  s_add_u32 m0, s60, 8192
  v_smfmac_f32_16x16x64_bf16 v[72:75], a[216:219], v[104:111], v38 abid:1
  s_nop 0
  v_smfmac_f32_16x16x64_bf16 v[76:79], a[220:223], v[104:111], v46 abid:1
  buffer_load_dwordx4 v3, s[16:19], s36 offen offset:0 nt lds
  s_waitcnt vmcnt(13) lgkmcnt(4)
  v_smfmac_f32_16x16x64_bf16 v[64:67], a[224:227], v[112:119], v23
  ds_read_b128 v[104:107], v10 offset:2048
  v_smfmac_f32_16x16x64_bf16 v[68:71], a[228:231], v[112:119], v31
  ds_read_b128 v[108:111], v11 offset:2048
  v_smfmac_f32_16x16x64_bf16 v[72:75], a[232:235], v[112:119], v39
  buffer_load_dwordx4 v3, s[16:19], s36 offen offset:1024 nt lds
  v_smfmac_f32_16x16x64_bf16 v[76:79], a[236:239], v[112:119], v47
  s_waitcnt vmcnt(8) lgkmcnt(4)
  v_smfmac_f32_16x16x64_bf16 v[64:67], a[240:243], v[120:127], v23 abid:1
  ds_read_b128 v[112:115], v8 offset:2304
  ds_read_b128 v[116:119], v9 offset:2304
  v_smfmac_f32_16x16x64_bf16 v[68:71], a[244:247], v[120:127], v31 abid:1
  s_add_u32 m0, s61, 8192
  v_smfmac_f32_16x16x64_bf16 v[72:75], a[248:251], v[120:127], v39 abid:1
  s_nop 0
  v_smfmac_f32_16x16x64_bf16 v[76:79], a[252:255], v[120:127], v47 abid:1
  buffer_load_dwordx4 v4, s[16:19], s36 offen offset:0 nt lds
  s_nop 7
  v_cvt_pk_bf16_f32 v236, v64, v65
  v_cvt_pk_bf16_f32 v237, v66, v67
  v_cvt_pk_bf16_f32 v238, v68, v69
  v_cvt_pk_bf16_f32 v239, v70, v71
  v_cvt_pk_bf16_f32 v240, v72, v73
  v_cvt_pk_bf16_f32 v241, v74, v75
  v_cvt_pk_bf16_f32 v242, v76, v77
  v_cvt_pk_bf16_f32 v243, v78, v79
  s_nop 1
  s_mov_b64 vcc, s[48:49]
  v_cndmask_b32_dpp v232, v240, v236, vcc quad_perm:[1,0,3,2] row_mask:0xf bank_mask:0xf
  v_cndmask_b32_dpp v233, v241, v237, vcc quad_perm:[1,0,3,2] row_mask:0xf bank_mask:0xf
  v_cndmask_b32_dpp v234, v242, v238, vcc quad_perm:[1,0,3,2] row_mask:0xf bank_mask:0xf
  v_cndmask_b32_dpp v235, v243, v239, vcc quad_perm:[1,0,3,2] row_mask:0xf bank_mask:0xf
  buffer_store_dwordx4 v[232:235], v7, s[20:23], s37 offen nt
  s_not_b64 vcc, s[48:49]
  s_nop 0
  v_cndmask_b32_dpp v232, v236, v240, vcc quad_perm:[1,0,3,2] row_mask:0xf bank_mask:0xf
  v_cndmask_b32_dpp v233, v237, v241, vcc quad_perm:[1,0,3,2] row_mask:0xf bank_mask:0xf
  v_cndmask_b32_dpp v234, v238, v242, vcc quad_perm:[1,0,3,2] row_mask:0xf bank_mask:0xf
  v_cndmask_b32_dpp v235, v239, v243, vcc quad_perm:[1,0,3,2] row_mask:0xf bank_mask:0xf
  buffer_store_dwordx4 v[232:235], v7, s[20:23], s37 offen offset:2048 nt
  s_add_u32 s41, s41, 32768
  s_and_b32 s41, s41, 0x7ffff
  s_add_u32 s37, s41, s42
  v_mov_b32 v64, v48
  v_mov_b32 v65, v49
  v_mov_b32 v66, v50
  v_mov_b32 v67, v51
  v_mov_b32 v68, v52
  v_mov_b32 v69, v53
  v_mov_b32 v70, v54
  v_mov_b32 v71, v55
  v_mov_b32 v72, v56
  v_mov_b32 v73, v57
  v_mov_b32 v74, v58
  v_mov_b32 v75, v59
  v_mov_b32 v76, v60
  v_mov_b32 v77, v61
  v_mov_b32 v78, v62
  v_mov_b32 v79, v63
  s_nop 1
Lloop:
  s_waitcnt lgkmcnt(4)
  v_smfmac_f32_16x16x64_bf16 v[80:83], a[0:3], v[96:103], v16
  ds_read_b128 v[120:123], v10 offset:2304
  ds_read_b128 v[124:127], v11 offset:2304
  v_smfmac_f32_16x16x64_bf16 v[84:87], a[4:7], v[96:103], v24
  buffer_load_dwordx4 v4, s[16:19], s36 offen offset:1024 nt lds
  ds_read_u16 v224, v192 offset:2048
  v_smfmac_f32_16x16x64_bf16 v[88:91], a[8:11], v[96:103], v32
  ds_read_u16 v225, v193 offset:2048
  ds_read_u16 v226, v194 offset:2048
  v_smfmac_f32_16x16x64_bf16 v[92:95], a[12:15], v[96:103], v40
  ds_read_u16 v227, v195 offset:2048
  s_waitcnt lgkmcnt(8)
  v_smfmac_f32_16x16x64_bf16 v[80:83], a[16:19], v[104:111], v16 abid:1
  ds_read_b128 v[96:99], v8 offset:2560
  ds_read_b128 v[100:103], v9 offset:2560
  s_add_u32 m0, s62, 8192
  v_smfmac_f32_16x16x64_bf16 v[84:87], a[20:23], v[104:111], v24 abid:1
  s_nop 0
  buffer_load_dwordx4 v5, s[16:19], s36 offen offset:0 nt lds
  v_smfmac_f32_16x16x64_bf16 v[88:91], a[24:27], v[104:111], v32 abid:1
  ds_read_u16 v228, v196 offset:2048
  ds_read_u16 v229, v197 offset:2048
  v_smfmac_f32_16x16x64_bf16 v[92:95], a[28:31], v[104:111], v40 abid:1
  ds_read_u16 v230, v198 offset:2048
  ds_read_u16 v231, v199 offset:2048
  s_waitcnt lgkmcnt(12)
  v_smfmac_f32_16x16x64_bf16 v[80:83], a[32:35], v[112:119], v17
  ds_read_b128 v[104:107], v10 offset:2560
  v_smfmac_f32_16x16x64_bf16 v[84:87], a[36:39], v[112:119], v25
  ds_read_b128 v[108:111], v11 offset:2560
  v_smfmac_f32_16x16x64_bf16 v[88:91], a[40:43], v[112:119], v33
  buffer_load_dwordx4 v5, s[16:19], s36 offen offset:1024 nt lds
  v_smfmac_f32_16x16x64_bf16 v[92:95], a[44:47], v[112:119], v41
  s_waitcnt lgkmcnt(12)
  v_smfmac_f32_16x16x64_bf16 v[80:83], a[48:51], v[120:127], v17 abid:1
  s_waitcnt lgkmcnt(2)
  v_lshl_or_b32 v224, v225, 16, v224
  v_lshl_or_b32 v226, v227, 16, v226
  v_lshl_or_b32 v228, v229, 16, v228
  v_smfmac_f32_16x16x64_bf16 v[84:87], a[52:55], v[120:127], v25 abid:1
  v_lshl_or_b32 v230, v231, 16, v230
  ds_read_b128 v[112:115], v8 offset:2816
  ds_read_b128 v[116:119], v9 offset:2816
  s_add_u32 m0, s63, 8192
  v_smfmac_f32_16x16x64_bf16 v[88:91], a[56:59], v[120:127], v33 abid:1
  s_nop 0
  buffer_load_dwordx4 v6, s[16:19], s36 offen offset:0 nt lds
  ds_read_u16 v244, v200 offset:2048
  v_smfmac_f32_16x16x64_bf16 v[92:95], a[60:63], v[120:127], v41 abid:1
  ds_read_u16 v245, v201 offset:2048
  ds_read_u16 v246, v202 offset:2048
  ds_read_u16 v247, v203 offset:2048
  v_smfmac_f32_16x16x64_bf16 v[80:83], v[128:131], v[224:231], v253
  v_smfmac_f32_16x16x64_bf16 v[84:87], v[132:135], v[224:231], v253
  v_smfmac_f32_16x16x64_bf16 v[88:91], v[136:139], v[224:231], v253
  v_smfmac_f32_16x16x64_bf16 v[92:95], v[140:143], v[224:231], v253
  s_waitcnt lgkmcnt(12)
  v_smfmac_f32_16x16x64_bf16 v[80:83], a[64:67], v[96:103], v18
  ds_read_b128 v[120:123], v10 offset:2816
  ds_read_b128 v[124:127], v11 offset:2816
  buffer_load_dwordx4 v6, s[16:19], s36 offen offset:1024 nt lds
  s_add_u32 s59, s59, 1
  v_smfmac_f32_16x16x64_bf16 v[84:87], a[68:71], v[96:103], v26
  s_add_u32 s40, s40, 32768
  s_and_b32 s40, s40, 0x7ffff
  s_add_u32 s36, s40, s56
  v_smfmac_f32_16x16x64_bf16 v[88:91], a[72:75], v[96:103], v34
  s_cmp_ge_u32 s59, 16
  s_cselect_b32 s36, 1073741824, s36
  ds_read_u16 v248, v204 offset:2048
  v_smfmac_f32_16x16x64_bf16 v[92:95], a[76:79], v[96:103], v42
  ds_read_u16 v249, v205 offset:2048
  ds_read_u16 v250, v206 offset:2048
  ds_read_u16 v251, v207 offset:2048
  s_waitcnt lgkmcnt(12)
  v_smfmac_f32_16x16x64_bf16 v[80:83], a[80:83], v[104:111], v18 abid:1
  ds_read_b128 v[96:99], v8 offset:3072
  v_smfmac_f32_16x16x64_bf16 v[84:87], a[84:87], v[104:111], v26 abid:1
  ds_read_b128 v[100:103], v9 offset:3072
  v_smfmac_f32_16x16x64_bf16 v[88:91], a[88:91], v[104:111], v34 abid:1
  v_smfmac_f32_16x16x64_bf16 v[92:95], a[92:95], v[104:111], v42 abid:1
  s_waitcnt lgkmcnt(12)
  v_smfmac_f32_16x16x64_bf16 v[80:83], a[96:99], v[112:119], v19
  s_waitcnt lgkmcnt(2)
  v_lshl_or_b32 v244, v245, 16, v244
  v_lshl_or_b32 v246, v247, 16, v246
  v_smfmac_f32_16x16x64_bf16 v[84:87], a[100:103], v[112:119], v27
  v_lshl_or_b32 v248, v249, 16, v248
  v_lshl_or_b32 v250, v251, 16, v250
  ds_read_b128 v[104:107], v10 offset:3072
  v_smfmac_f32_16x16x64_bf16 v[88:91], a[104:107], v[112:119], v35
  ds_read_b128 v[108:111], v11 offset:3072
  ds_read_u16 v224, v208 offset:2048
  ds_read_u16 v225, v209 offset:2048
  v_smfmac_f32_16x16x64_bf16 v[92:95], a[108:111], v[112:119], v43
  ds_read_u16 v226, v210 offset:2048
  ds_read_u16 v227, v211 offset:2048
  v_smfmac_f32_16x16x64_bf16 v[80:83], v[144:147], v[244:251], v253
  v_smfmac_f32_16x16x64_bf16 v[84:87], v[148:151], v[244:251], v253
  v_smfmac_f32_16x16x64_bf16 v[88:91], v[152:155], v[244:251], v253
  v_smfmac_f32_16x16x64_bf16 v[92:95], v[156:159], v[244:251], v253
  s_waitcnt lgkmcnt(12)
  v_smfmac_f32_16x16x64_bf16 v[80:83], a[112:115], v[120:127], v19 abid:1
  ds_read_b128 v[112:115], v8 offset:3328
  ds_read_b128 v[116:119], v9 offset:3328
  v_smfmac_f32_16x16x64_bf16 v[84:87], a[116:119], v[120:127], v27 abid:1
  ds_read_u16 v228, v212 offset:2048
  ds_read_u16 v229, v213 offset:2048
  v_smfmac_f32_16x16x64_bf16 v[88:91], a[120:123], v[120:127], v35 abid:1
  ds_read_u16 v230, v214 offset:2048
  v_smfmac_f32_16x16x64_bf16 v[92:95], a[124:127], v[120:127], v43 abid:1
  ds_read_u16 v231, v215 offset:2048
  s_waitcnt lgkmcnt(12)
  v_smfmac_f32_16x16x64_bf16 v[80:83], a[128:131], v[96:103], v20
  ds_read_b128 v[120:123], v10 offset:3328
  v_smfmac_f32_16x16x64_bf16 v[84:87], a[132:135], v[96:103], v28
  ds_read_b128 v[124:127], v11 offset:3328
  v_smfmac_f32_16x16x64_bf16 v[88:91], a[136:139], v[96:103], v36
  v_smfmac_f32_16x16x64_bf16 v[92:95], a[140:143], v[96:103], v44
  s_waitcnt lgkmcnt(12)
  v_smfmac_f32_16x16x64_bf16 v[80:83], a[144:147], v[104:111], v20 abid:1
  s_waitcnt lgkmcnt(2)
  v_lshl_or_b32 v224, v225, 16, v224
  v_lshl_or_b32 v226, v227, 16, v226
  v_smfmac_f32_16x16x64_bf16 v[84:87], a[148:151], v[104:111], v28 abid:1
  v_lshl_or_b32 v228, v229, 16, v228
  v_lshl_or_b32 v230, v231, 16, v230
  ds_read_b128 v[96:99], v8 offset:3584
  v_smfmac_f32_16x16x64_bf16 v[88:91], a[152:155], v[104:111], v36 abid:1
  ds_read_b128 v[100:103], v9 offset:3584
  ds_read_u16 v244, v216 offset:2048
  ds_read_u16 v245, v217 offset:2048
  v_smfmac_f32_16x16x64_bf16 v[92:95], a[156:159], v[104:111], v44 abid:1
  ds_read_u16 v246, v218 offset:2048
  ds_read_u16 v247, v219 offset:2048
  v_smfmac_f32_16x16x64_bf16 v[80:83], v[160:163], v[224:231], v253
  v_smfmac_f32_16x16x64_bf16 v[84:87], v[164:167], v[224:231], v253
  v_smfmac_f32_16x16x64_bf16 v[88:91], v[168:171], v[224:231], v253
  v_smfmac_f32_16x16x64_bf16 v[92:95], v[172:175], v[224:231], v253
  s_waitcnt lgkmcnt(12)
  v_smfmac_f32_16x16x64_bf16 v[80:83], a[160:163], v[112:119], v21
  ds_read_b128 v[104:107], v10 offset:3584
  ds_read_b128 v[108:111], v11 offset:3584
  v_smfmac_f32_16x16x64_bf16 v[84:87], a[164:167], v[112:119], v29
  ds_read_u16 v248, v220 offset:2048
  ds_read_u16 v249, v221 offset:2048
  v_smfmac_f32_16x16x64_bf16 v[88:91], a[168:171], v[112:119], v37
  ds_read_u16 v250, v222 offset:2048
  v_smfmac_f32_16x16x64_bf16 v[92:95], a[172:175], v[112:119], v45
  ds_read_u16 v251, v223 offset:2048
  s_waitcnt lgkmcnt(12)
  v_smfmac_f32_16x16x64_bf16 v[80:83], a[176:179], v[120:127], v21 abid:1
  ds_read_b128 v[112:115], v8 offset:3840
  v_smfmac_f32_16x16x64_bf16 v[84:87], a[180:183], v[120:127], v29 abid:1
  ds_read_b128 v[116:119], v9 offset:3840
  v_smfmac_f32_16x16x64_bf16 v[88:91], a[184:187], v[120:127], v37 abid:1
  v_smfmac_f32_16x16x64_bf16 v[92:95], a[188:191], v[120:127], v45 abid:1
  s_waitcnt lgkmcnt(12)
  v_smfmac_f32_16x16x64_bf16 v[80:83], a[192:195], v[96:103], v22
  s_waitcnt lgkmcnt(2)
  v_lshl_or_b32 v244, v245, 16, v244
  v_smfmac_f32_16x16x64_bf16 v[84:87], a[196:199], v[96:103], v30
  v_lshl_or_b32 v246, v247, 16, v246
  v_lshl_or_b32 v248, v249, 16, v248
  v_smfmac_f32_16x16x64_bf16 v[88:91], a[200:203], v[96:103], v38
  v_lshl_or_b32 v250, v251, 16, v250
  ds_read_b128 v[120:123], v10 offset:3840
  v_smfmac_f32_16x16x64_bf16 v[92:95], a[204:207], v[96:103], v46
  ds_read_b128 v[124:127], v11 offset:3840
  v_smfmac_f32_16x16x64_bf16 v[80:83], v[176:179], v[244:251], v253
  v_smfmac_f32_16x16x64_bf16 v[84:87], v[180:183], v[244:251], v253
  v_smfmac_f32_16x16x64_bf16 v[88:91], v[184:187], v[244:251], v253
  v_smfmac_f32_16x16x64_bf16 v[92:95], v[188:191], v[244:251], v253
  s_cmp_gt_u32 s39, 4
  s_cbranch_scc1 Lslow_b0
Lslowback_b0:
  s_waitcnt vmcnt(22)
  s_barrier
  s_waitcnt lgkmcnt(8)
  v_smfmac_f32_16x16x64_bf16 v[80:83], a[208:211], v[104:111], v22 abid:1
  ds_read_b128 v[96:99], v8 offset:4096
  ds_read_b128 v[100:103], v9 offset:4096
  v_smfmac_f32_16x16x64_bf16 v[84:87], a[212:215], v[104:111], v30 abid:1
  s_add_u32 m0, s60, 0
  v_smfmac_f32_16x16x64_bf16 v[88:91], a[216:219], v[104:111], v38 abid:1
  s_nop 0
  v_smfmac_f32_16x16x64_bf16 v[92:95], a[220:223], v[104:111], v46 abid:1
  buffer_load_dwordx4 v3, s[16:19], s36 offen offset:0 nt lds
  s_waitcnt lgkmcnt(4)
  v_smfmac_f32_16x16x64_bf16 v[80:83], a[224:227], v[112:119], v23
  ds_read_b128 v[104:107], v10 offset:4096
  v_smfmac_f32_16x16x64_bf16 v[84:87], a[228:231], v[112:119], v31
  ds_read_b128 v[108:111], v11 offset:4096
  v_smfmac_f32_16x16x64_bf16 v[88:91], a[232:235], v[112:119], v39
  buffer_load_dwordx4 v3, s[16:19], s36 offen offset:1024 nt lds
  v_smfmac_f32_16x16x64_bf16 v[92:95], a[236:239], v[112:119], v47
  s_waitcnt lgkmcnt(4)
  v_smfmac_f32_16x16x64_bf16 v[80:83], a[240:243], v[120:127], v23 abid:1
  ds_read_b128 v[112:115], v8 offset:4352
  ds_read_b128 v[116:119], v9 offset:4352
  v_smfmac_f32_16x16x64_bf16 v[84:87], a[244:247], v[120:127], v31 abid:1
  s_add_u32 m0, s61, 0
  v_smfmac_f32_16x16x64_bf16 v[88:91], a[248:251], v[120:127], v39 abid:1
  s_nop 0
  v_smfmac_f32_16x16x64_bf16 v[92:95], a[252:255], v[120:127], v47 abid:1
  buffer_load_dwordx4 v4, s[16:19], s36 offen offset:0 nt lds
  s_waitcnt lgkmcnt(4)
  v_smfmac_f32_16x16x64_bf16 v[64:67], a[0:3], v[96:103], v16
  ds_read_b128 v[120:123], v10 offset:4352
  ds_read_b128 v[124:127], v11 offset:4352
  v_smfmac_f32_16x16x64_bf16 v[68:71], a[4:7], v[96:103], v24
  buffer_load_dwordx4 v4, s[16:19], s36 offen offset:1024 nt lds
  ds_read_u16 v224, v192 offset:4096
  v_smfmac_f32_16x16x64_bf16 v[72:75], a[8:11], v[96:103], v32
  ds_read_u16 v225, v193 offset:4096
  ds_read_u16 v226, v194 offset:4096
  v_smfmac_f32_16x16x64_bf16 v[76:79], a[12:15], v[96:103], v40
  ds_read_u16 v227, v195 offset:4096
  s_waitcnt lgkmcnt(8)
  v_smfmac_f32_16x16x64_bf16 v[64:67], a[16:19], v[104:111], v16 abid:1
  ds_read_b128 v[96:99], v8 offset:4608
  ds_read_b128 v[100:103], v9 offset:4608
  s_add_u32 m0, s62, 0
  v_smfmac_f32_16x16x64_bf16 v[68:71], a[20:23], v[104:111], v24 abid:1
  s_nop 0
  buffer_load_dwordx4 v5, s[16:19], s36 offen offset:0 nt lds
  v_smfmac_f32_16x16x64_bf16 v[72:75], a[24:27], v[104:111], v32 abid:1
  ds_read_u16 v228, v196 offset:4096
  ds_read_u16 v229, v197 offset:4096
  v_smfmac_f32_16x16x64_bf16 v[76:79], a[28:31], v[104:111], v40 abid:1
  ds_read_u16 v230, v198 offset:4096
  ds_read_u16 v231, v199 offset:4096
  s_waitcnt lgkmcnt(12)
  v_smfmac_f32_16x16x64_bf16 v[64:67], a[32:35], v[112:119], v17
  ds_read_b128 v[104:107], v10 offset:4608
  v_smfmac_f32_16x16x64_bf16 v[68:71], a[36:39], v[112:119], v25
  ds_read_b128 v[108:111], v11 offset:4608
  v_smfmac_f32_16x16x64_bf16 v[72:75], a[40:43], v[112:119], v33
  buffer_load_dwordx4 v5, s[16:19], s36 offen offset:1024 nt lds
  v_smfmac_f32_16x16x64_bf16 v[76:79], a[44:47], v[112:119], v41
  s_waitcnt lgkmcnt(12)
  v_smfmac_f32_16x16x64_bf16 v[64:67], a[48:51], v[120:127], v17 abid:1
  s_waitcnt lgkmcnt(2)
  v_lshl_or_b32 v224, v225, 16, v224
  v_lshl_or_b32 v226, v227, 16, v226
  v_lshl_or_b32 v228, v229, 16, v228
  v_smfmac_f32_16x16x64_bf16 v[68:71], a[52:55], v[120:127], v25 abid:1
  v_lshl_or_b32 v230, v231, 16, v230
  ds_read_b128 v[112:115], v8 offset:4864
  ds_read_b128 v[116:119], v9 offset:4864
  s_add_u32 m0, s63, 0
  v_smfmac_f32_16x16x64_bf16 v[72:75], a[56:59], v[120:127], v33 abid:1
  s_nop 0
  buffer_load_dwordx4 v6, s[16:19], s36 offen offset:0 nt lds
  ds_read_u16 v244, v200 offset:4096
  v_smfmac_f32_16x16x64_bf16 v[76:79], a[60:63], v[120:127], v41 abid:1
  ds_read_u16 v245, v201 offset:4096
  ds_read_u16 v246, v202 offset:4096
  ds_read_u16 v247, v203 offset:4096
  v_smfmac_f32_16x16x64_bf16 v[64:67], v[128:131], v[224:231], v253
  v_smfmac_f32_16x16x64_bf16 v[68:71], v[132:135], v[224:231], v253
  v_smfmac_f32_16x16x64_bf16 v[72:75], v[136:139], v[224:231], v253
  v_smfmac_f32_16x16x64_bf16 v[76:79], v[140:143], v[224:231], v253
  s_waitcnt lgkmcnt(12)
  v_smfmac_f32_16x16x64_bf16 v[64:67], a[64:67], v[96:103], v18
  ds_read_b128 v[120:123], v10 offset:4864
  ds_read_b128 v[124:127], v11 offset:4864
  v_cvt_pk_bf16_f32 v236, v80, v81
  v_cvt_pk_bf16_f32 v237, v82, v83
  v_cvt_pk_bf16_f32 v238, v84, v85
  v_cvt_pk_bf16_f32 v239, v86, v87
  v_smfmac_f32_16x16x64_bf16 v[68:71], a[68:71], v[96:103], v26
  v_cvt_pk_bf16_f32 v240, v88, v89
  v_cvt_pk_bf16_f32 v241, v90, v91
  v_cvt_pk_bf16_f32 v242, v92, v93
  v_cvt_pk_bf16_f32 v243, v94, v95
  buffer_load_dwordx4 v6, s[16:19], s36 offen offset:1024 nt lds
  v_smfmac_f32_16x16x64_bf16 v[72:75], a[72:75], v[96:103], v34
  s_add_u32 s59, s59, 1
  s_add_u32 s40, s40, 32768
  s_and_b32 s40, s40, 0x7ffff
  s_add_u32 s36, s40, s56
  s_cmp_ge_u32 s59, 16
  v_smfmac_f32_16x16x64_bf16 v[76:79], a[76:79], v[96:103], v42
  s_cselect_b32 s36, 1073741824, s36
  ds_read_u16 v248, v204 offset:4096
  ds_read_u16 v249, v205 offset:4096
  ds_read_u16 v250, v206 offset:4096
  ds_read_u16 v251, v207 offset:4096
  s_waitcnt lgkmcnt(12)
  v_smfmac_f32_16x16x64_bf16 v[64:67], a[80:83], v[104:111], v18 abid:1
  ds_read_b128 v[96:99], v8 offset:5120
  ds_read_b128 v[100:103], v9 offset:5120
  v_smfmac_f32_16x16x64_bf16 v[68:71], a[84:87], v[104:111], v26 abid:1
  s_mov_b64 vcc, s[48:49]
  v_cndmask_b32_dpp v232, v240, v236, vcc quad_perm:[1,0,3,2] row_mask:0xf bank_mask:0xf
  v_smfmac_f32_16x16x64_bf16 v[72:75], a[88:91], v[104:111], v34 abid:1
  v_cndmask_b32_dpp v233, v241, v237, vcc quad_perm:[1,0,3,2] row_mask:0xf bank_mask:0xf
  v_cndmask_b32_dpp v234, v242, v238, vcc quad_perm:[1,0,3,2] row_mask:0xf bank_mask:0xf
  v_smfmac_f32_16x16x64_bf16 v[76:79], a[92:95], v[104:111], v42 abid:1
  v_cndmask_b32_dpp v235, v243, v239, vcc quad_perm:[1,0,3,2] row_mask:0xf bank_mask:0xf
  buffer_store_dwordx4 v[232:235], v7, s[20:23], s37 offen nt
  s_waitcnt lgkmcnt(12)
  v_smfmac_f32_16x16x64_bf16 v[64:67], a[96:99], v[112:119], v19
  s_waitcnt lgkmcnt(2)
  v_lshl_or_b32 v244, v245, 16, v244
  v_lshl_or_b32 v246, v247, 16, v246
  v_smfmac_f32_16x16x64_bf16 v[68:71], a[100:103], v[112:119], v27
  v_lshl_or_b32 v248, v249, 16, v248
  v_lshl_or_b32 v250, v251, 16, v250
  ds_read_b128 v[104:107], v10 offset:5120
  v_smfmac_f32_16x16x64_bf16 v[72:75], a[104:107], v[112:119], v35
  ds_read_b128 v[108:111], v11 offset:5120
  ds_read_u16 v224, v208 offset:4096
  ds_read_u16 v225, v209 offset:4096
  v_smfmac_f32_16x16x64_bf16 v[76:79], a[108:111], v[112:119], v43
  ds_read_u16 v226, v210 offset:4096
  ds_read_u16 v227, v211 offset:4096
  v_smfmac_f32_16x16x64_bf16 v[64:67], v[144:147], v[244:251], v253
  v_smfmac_f32_16x16x64_bf16 v[68:71], v[148:151], v[244:251], v253
  v_smfmac_f32_16x16x64_bf16 v[72:75], v[152:155], v[244:251], v253
  v_smfmac_f32_16x16x64_bf16 v[76:79], v[156:159], v[244:251], v253
  s_waitcnt lgkmcnt(12)
  v_smfmac_f32_16x16x64_bf16 v[64:67], a[112:115], v[120:127], v19 abid:1
  ds_read_b128 v[112:115], v8 offset:5376
  ds_read_b128 v[116:119], v9 offset:5376
  v_smfmac_f32_16x16x64_bf16 v[68:71], a[116:119], v[120:127], v27 abid:1
  ds_read_u16 v228, v212 offset:4096
  ds_read_u16 v229, v213 offset:4096
  v_smfmac_f32_16x16x64_bf16 v[72:75], a[120:123], v[120:127], v35 abid:1
  ds_read_u16 v230, v214 offset:4096
  v_smfmac_f32_16x16x64_bf16 v[76:79], a[124:127], v[120:127], v43 abid:1
  ds_read_u16 v231, v215 offset:4096
  s_waitcnt lgkmcnt(12)
  v_smfmac_f32_16x16x64_bf16 v[64:67], a[128:131], v[96:103], v20
  ds_read_b128 v[120:123], v10 offset:5376
  ds_read_b128 v[124:127], v11 offset:5376
  s_not_b64 vcc, s[48:49]
  v_smfmac_f32_16x16x64_bf16 v[68:71], a[132:135], v[96:103], v28
  s_nop 0
  v_cndmask_b32_dpp v232, v236, v240, vcc quad_perm:[1,0,3,2] row_mask:0xf bank_mask:0xf
  v_cndmask_b32_dpp v233, v237, v241, vcc quad_perm:[1,0,3,2] row_mask:0xf bank_mask:0xf
  v_smfmac_f32_16x16x64_bf16 v[72:75], a[136:139], v[96:103], v36
  v_cndmask_b32_dpp v234, v238, v242, vcc quad_perm:[1,0,3,2] row_mask:0xf bank_mask:0xf
  v_cndmask_b32_dpp v235, v239, v243, vcc quad_perm:[1,0,3,2] row_mask:0xf bank_mask:0xf
  buffer_store_dwordx4 v[232:235], v7, s[20:23], s37 offen offset:2048 nt
  v_smfmac_f32_16x16x64_bf16 v[76:79], a[140:143], v[96:103], v44
  s_add_u32 s41, s41, 32768
  s_and_b32 s41, s41, 0x7ffff
  s_add_u32 s37, s41, s42
  s_waitcnt lgkmcnt(12)
  v_smfmac_f32_16x16x64_bf16 v[64:67], a[144:147], v[104:111], v20 abid:1
  s_waitcnt lgkmcnt(2)
  v_lshl_or_b32 v224, v225, 16, v224
  v_lshl_or_b32 v226, v227, 16, v226
  v_smfmac_f32_16x16x64_bf16 v[68:71], a[148:151], v[104:111], v28 abid:1
  v_lshl_or_b32 v228, v229, 16, v228
  v_lshl_or_b32 v230, v231, 16, v230
  ds_read_b128 v[96:99], v8 offset:5632
  v_smfmac_f32_16x16x64_bf16 v[72:75], a[152:155], v[104:111], v36 abid:1
  ds_read_b128 v[100:103], v9 offset:5632
  ds_read_u16 v244, v216 offset:4096
  ds_read_u16 v245, v217 offset:4096
  v_smfmac_f32_16x16x64_bf16 v[76:79], a[156:159], v[104:111], v44 abid:1
  ds_read_u16 v246, v218 offset:4096
  ds_read_u16 v247, v219 offset:4096
  v_smfmac_f32_16x16x64_bf16 v[64:67], v[160:163], v[224:231], v253
  v_smfmac_f32_16x16x64_bf16 v[68:71], v[164:167], v[224:231], v253
  v_smfmac_f32_16x16x64_bf16 v[72:75], v[168:171], v[224:231], v253
  v_smfmac_f32_16x16x64_bf16 v[76:79], v[172:175], v[224:231], v253
  s_waitcnt lgkmcnt(12)
  v_smfmac_f32_16x16x64_bf16 v[64:67], a[160:163], v[112:119], v21
  ds_read_b128 v[104:107], v10 offset:5632
  ds_read_b128 v[108:111], v11 offset:5632
  v_smfmac_f32_16x16x64_bf16 v[68:71], a[164:167], v[112:119], v29
  ds_read_u16 v248, v220 offset:4096
  ds_read_u16 v249, v221 offset:4096
  v_smfmac_f32_16x16x64_bf16 v[72:75], a[168:171], v[112:119], v37
  ds_read_u16 v250, v222 offset:4096
  v_smfmac_f32_16x16x64_bf16 v[76:79], a[172:175], v[112:119], v45
  ds_read_u16 v251, v223 offset:4096
  s_waitcnt lgkmcnt(12)
  v_smfmac_f32_16x16x64_bf16 v[64:67], a[176:179], v[120:127], v21 abid:1
  ds_read_b128 v[112:115], v8 offset:5888
  ds_read_b128 v[116:119], v9 offset:5888
  v_mov_b32 v80, v48
  v_smfmac_f32_16x16x64_bf16 v[68:71], a[180:183], v[120:127], v29 abid:1
  v_mov_b32 v81, v49
  v_mov_b32 v82, v50
  v_mov_b32 v83, v51
  v_smfmac_f32_16x16x64_bf16 v[72:75], a[184:187], v[120:127], v37 abid:1
  v_mov_b32 v84, v52
  v_mov_b32 v85, v53
  v_smfmac_f32_16x16x64_bf16 v[76:79], a[188:191], v[120:127], v45 abid:1
  v_mov_b32 v86, v54
  v_mov_b32 v87, v55
  s_waitcnt lgkmcnt(12)
  v_smfmac_f32_16x16x64_bf16 v[64:67], a[192:195], v[96:103], v22
  s_waitcnt lgkmcnt(2)
  v_lshl_or_b32 v244, v245, 16, v244
  v_smfmac_f32_16x16x64_bf16 v[68:71], a[196:199], v[96:103], v30
  v_lshl_or_b32 v246, v247, 16, v246
  v_lshl_or_b32 v248, v249, 16, v248
  v_smfmac_f32_16x16x64_bf16 v[72:75], a[200:203], v[96:103], v38
  v_lshl_or_b32 v250, v251, 16, v250
  ds_read_b128 v[120:123], v10 offset:5888
  v_smfmac_f32_16x16x64_bf16 v[76:79], a[204:207], v[96:103], v46
  ds_read_b128 v[124:127], v11 offset:5888
  v_smfmac_f32_16x16x64_bf16 v[64:67], v[176:179], v[244:251], v253
  v_smfmac_f32_16x16x64_bf16 v[68:71], v[180:183], v[244:251], v253
  v_smfmac_f32_16x16x64_bf16 v[72:75], v[184:187], v[244:251], v253
  v_smfmac_f32_16x16x64_bf16 v[76:79], v[188:191], v[244:251], v253
  s_cmp_gt_u32 s39, 4
  s_cbranch_scc1 Lslow_b1
Lslowback_b1:
  s_waitcnt vmcnt(20)
  s_barrier
  s_waitcnt lgkmcnt(8)
  v_smfmac_f32_16x16x64_bf16 v[64:67], a[208:211], v[104:111], v22 abid:1
  ds_read_b128 v[96:99], v8 offset:6144
  ds_read_b128 v[100:103], v9 offset:6144
  v_smfmac_f32_16x16x64_bf16 v[68:71], a[212:215], v[104:111], v30 abid:1
  s_add_u32 m0, s60, 2048
  v_smfmac_f32_16x16x64_bf16 v[72:75], a[216:219], v[104:111], v38 abid:1
  s_nop 0
  v_smfmac_f32_16x16x64_bf16 v[76:79], a[220:223], v[104:111], v46 abid:1
  buffer_load_dwordx4 v3, s[16:19], s36 offen offset:0 nt lds
  s_waitcnt lgkmcnt(4)
  v_smfmac_f32_16x16x64_bf16 v[64:67], a[224:227], v[112:119], v23
  ds_read_b128 v[104:107], v10 offset:6144
  ds_read_b128 v[108:111], v11 offset:6144
  v_mov_b32 v88, v56
  v_smfmac_f32_16x16x64_bf16 v[68:71], a[228:231], v[112:119], v31
  v_mov_b32 v89, v57
  v_mov_b32 v90, v58
  v_mov_b32 v91, v59
  v_smfmac_f32_16x16x64_bf16 v[72:75], a[232:235], v[112:119], v39
  v_mov_b32 v92, v60
  v_mov_b32 v93, v61
  v_mov_b32 v94, v62
  v_smfmac_f32_16x16x64_bf16 v[76:79], a[236:239], v[112:119], v47
  v_mov_b32 v95, v63
  buffer_load_dwordx4 v3, s[16:19], s36 offen offset:1024 nt lds
  s_waitcnt lgkmcnt(4)
  v_smfmac_f32_16x16x64_bf16 v[64:67], a[240:243], v[120:127], v23 abid:1
  ds_read_b128 v[112:115], v8 offset:6400
  ds_read_b128 v[116:119], v9 offset:6400
  v_smfmac_f32_16x16x64_bf16 v[68:71], a[244:247], v[120:127], v31 abid:1
  s_add_u32 m0, s61, 2048
  v_smfmac_f32_16x16x64_bf16 v[72:75], a[248:251], v[120:127], v39 abid:1
  s_nop 0
  v_smfmac_f32_16x16x64_bf16 v[76:79], a[252:255], v[120:127], v47 abid:1
  buffer_load_dwordx4 v4, s[16:19], s36 offen offset:0 nt lds
  s_waitcnt lgkmcnt(4)
  v_smfmac_f32_16x16x64_bf16 v[80:83], a[0:3], v[96:103], v16
  ds_read_b128 v[120:123], v10 offset:6400
  ds_read_b128 v[124:127], v11 offset:6400
  v_smfmac_f32_16x16x64_bf16 v[84:87], a[4:7], v[96:103], v24
  buffer_load_dwordx4 v4, s[16:19], s36 offen offset:1024 nt lds
  ds_read_u16 v224, v192 offset:6144
  v_smfmac_f32_16x16x64_bf16 v[88:91], a[8:11], v[96:103], v32
  ds_read_u16 v225, v193 offset:6144
  ds_read_u16 v226, v194 offset:6144
  v_smfmac_f32_16x16x64_bf16 v[92:95], a[12:15], v[96:103], v40
  ds_read_u16 v227, v195 offset:6144
  s_waitcnt lgkmcnt(8)
  v_smfmac_f32_16x16x64_bf16 v[80:83], a[16:19], v[104:111], v16 abid:1
  ds_read_b128 v[96:99], v8 offset:6656
  ds_read_b128 v[100:103], v9 offset:6656
  s_add_u32 m0, s62, 2048
  v_smfmac_f32_16x16x64_bf16 v[84:87], a[20:23], v[104:111], v24 abid:1
  s_nop 0
  buffer_load_dwordx4 v5, s[16:19], s36 offen offset:0 nt lds
  v_smfmac_f32_16x16x64_bf16 v[88:91], a[24:27], v[104:111], v32 abid:1
  ds_read_u16 v228, v196 offset:6144
  ds_read_u16 v229, v197 offset:6144
  v_smfmac_f32_16x16x64_bf16 v[92:95], a[28:31], v[104:111], v40 abid:1
  ds_read_u16 v230, v198 offset:6144
  ds_read_u16 v231, v199 offset:6144
  s_waitcnt lgkmcnt(12)
  v_smfmac_f32_16x16x64_bf16 v[80:83], a[32:35], v[112:119], v17
  ds_read_b128 v[104:107], v10 offset:6656
  v_smfmac_f32_16x16x64_bf16 v[84:87], a[36:39], v[112:119], v25
  ds_read_b128 v[108:111], v11 offset:6656
  v_smfmac_f32_16x16x64_bf16 v[88:91], a[40:43], v[112:119], v33
  buffer_load_dwordx4 v5, s[16:19], s36 offen offset:1024 nt lds
  v_smfmac_f32_16x16x64_bf16 v[92:95], a[44:47], v[112:119], v41
  s_waitcnt lgkmcnt(12)
  v_smfmac_f32_16x16x64_bf16 v[80:83], a[48:51], v[120:127], v17 abid:1
  s_waitcnt lgkmcnt(2)
  v_lshl_or_b32 v224, v225, 16, v224
  v_lshl_or_b32 v226, v227, 16, v226
  v_lshl_or_b32 v228, v229, 16, v228
  v_smfmac_f32_16x16x64_bf16 v[84:87], a[52:55], v[120:127], v25 abid:1
  v_lshl_or_b32 v230, v231, 16, v230
  ds_read_b128 v[112:115], v8 offset:6912
  ds_read_b128 v[116:119], v9 offset:6912
  s_add_u32 m0, s63, 2048
  v_smfmac_f32_16x16x64_bf16 v[88:91], a[56:59], v[120:127], v33 abid:1
  s_nop 0
  buffer_load_dwordx4 v6, s[16:19], s36 offen offset:0 nt lds
  ds_read_u16 v244, v200 offset:6144
  v_smfmac_f32_16x16x64_bf16 v[92:95], a[60:63], v[120:127], v41 abid:1
  ds_read_u16 v245, v201 offset:6144
  ds_read_u16 v246, v202 offset:6144
  ds_read_u16 v247, v203 offset:6144
  v_smfmac_f32_16x16x64_bf16 v[80:83], v[128:131], v[224:231], v253
  v_smfmac_f32_16x16x64_bf16 v[84:87], v[132:135], v[224:231], v253
  v_smfmac_f32_16x16x64_bf16 v[88:91], v[136:139], v[224:231], v253
  v_smfmac_f32_16x16x64_bf16 v[92:95], v[140:143], v[224:231], v253
  s_waitcnt lgkmcnt(12)
  v_smfmac_f32_16x16x64_bf16 v[80:83], a[64:67], v[96:103], v18
  ds_read_b128 v[120:123], v10 offset:6912
  ds_read_b128 v[124:127], v11 offset:6912
  v_cvt_pk_bf16_f32 v236, v64, v65
  v_cvt_pk_bf16_f32 v237, v66, v67
  v_cvt_pk_bf16_f32 v238, v68, v69
  v_cvt_pk_bf16_f32 v239, v70, v71
  v_smfmac_f32_16x16x64_bf16 v[84:87], a[68:71], v[96:103], v26
  v_cvt_pk_bf16_f32 v240, v72, v73
  v_cvt_pk_bf16_f32 v241, v74, v75
  v_cvt_pk_bf16_f32 v242, v76, v77
  v_cvt_pk_bf16_f32 v243, v78, v79
  buffer_load_dwordx4 v6, s[16:19], s36 offen offset:1024 nt lds
  v_smfmac_f32_16x16x64_bf16 v[88:91], a[72:75], v[96:103], v34
  s_add_u32 s59, s59, 1
  s_add_u32 s40, s40, 32768
  s_and_b32 s40, s40, 0x7ffff
  s_add_u32 s36, s40, s56
  s_cmp_ge_u32 s59, 16
  v_smfmac_f32_16x16x64_bf16 v[92:95], a[76:79], v[96:103], v42
  s_cselect_b32 s36, 1073741824, s36
  ds_read_u16 v248, v204 offset:6144
  ds_read_u16 v249, v205 offset:6144
  ds_read_u16 v250, v206 offset:6144
  ds_read_u16 v251, v207 offset:6144
  s_waitcnt lgkmcnt(12)
  v_smfmac_f32_16x16x64_bf16 v[80:83], a[80:83], v[104:111], v18 abid:1
  ds_read_b128 v[96:99], v8 offset:7168
  ds_read_b128 v[100:103], v9 offset:7168
  v_smfmac_f32_16x16x64_bf16 v[84:87], a[84:87], v[104:111], v26 abid:1
  s_mov_b64 vcc, s[48:49]
  v_cndmask_b32_dpp v232, v240, v236, vcc quad_perm:[1,0,3,2] row_mask:0xf bank_mask:0xf
  v_smfmac_f32_16x16x64_bf16 v[88:91], a[88:91], v[104:111], v34 abid:1
  v_cndmask_b32_dpp v233, v241, v237, vcc quad_perm:[1,0,3,2] row_mask:0xf bank_mask:0xf
  v_cndmask_b32_dpp v234, v242, v238, vcc quad_perm:[1,0,3,2] row_mask:0xf bank_mask:0xf
  v_smfmac_f32_16x16x64_bf16 v[92:95], a[92:95], v[104:111], v42 abid:1
  v_cndmask_b32_dpp v235, v243, v239, vcc quad_perm:[1,0,3,2] row_mask:0xf bank_mask:0xf
  buffer_store_dwordx4 v[232:235], v7, s[20:23], s37 offen nt
  s_waitcnt lgkmcnt(12)
  v_smfmac_f32_16x16x64_bf16 v[80:83], a[96:99], v[112:119], v19
  s_waitcnt lgkmcnt(2)
  v_lshl_or_b32 v244, v245, 16, v244
  v_lshl_or_b32 v246, v247, 16, v246
  v_smfmac_f32_16x16x64_bf16 v[84:87], a[100:103], v[112:119], v27
  v_lshl_or_b32 v248, v249, 16, v248
  v_lshl_or_b32 v250, v251, 16, v250
  ds_read_b128 v[104:107], v10 offset:7168
  v_smfmac_f32_16x16x64_bf16 v[88:91], a[104:107], v[112:119], v35
  ds_read_b128 v[108:111], v11 offset:7168
  ds_read_u16 v224, v208 offset:6144
  ds_read_u16 v225, v209 offset:6144
  v_smfmac_f32_16x16x64_bf16 v[92:95], a[108:111], v[112:119], v43
  ds_read_u16 v226, v210 offset:6144
  ds_read_u16 v227, v211 offset:6144
  v_smfmac_f32_16x16x64_bf16 v[80:83], v[144:147], v[244:251], v253
  v_smfmac_f32_16x16x64_bf16 v[84:87], v[148:151], v[244:251], v253
  v_smfmac_f32_16x16x64_bf16 v[88:91], v[152:155], v[244:251], v253
  v_smfmac_f32_16x16x64_bf16 v[92:95], v[156:159], v[244:251], v253
  s_waitcnt lgkmcnt(12)
  v_smfmac_f32_16x16x64_bf16 v[80:83], a[112:115], v[120:127], v19 abid:1
  ds_read_b128 v[112:115], v8 offset:7424
  ds_read_b128 v[116:119], v9 offset:7424
  v_smfmac_f32_16x16x64_bf16 v[84:87], a[116:119], v[120:127], v27 abid:1
  ds_read_u16 v228, v212 offset:6144
  ds_read_u16 v229, v213 offset:6144
  v_smfmac_f32_16x16x64_bf16 v[88:91], a[120:123], v[120:127], v35 abid:1
  ds_read_u16 v230, v214 offset:6144
  v_smfmac_f32_16x16x64_bf16 v[92:95], a[124:127], v[120:127], v43 abid:1
  ds_read_u16 v231, v215 offset:6144
  s_waitcnt lgkmcnt(12)
  v_smfmac_f32_16x16x64_bf16 v[80:83], a[128:131], v[96:103], v20
  ds_read_b128 v[120:123], v10 offset:7424
  ds_read_b128 v[124:127], v11 offset:7424
  s_not_b64 vcc, s[48:49]
  v_smfmac_f32_16x16x64_bf16 v[84:87], a[132:135], v[96:103], v28
  s_nop 0
  v_cndmask_b32_dpp v232, v236, v240, vcc quad_perm:[1,0,3,2] row_mask:0xf bank_mask:0xf
  v_cndmask_b32_dpp v233, v237, v241, vcc quad_perm:[1,0,3,2] row_mask:0xf bank_mask:0xf
  v_smfmac_f32_16x16x64_bf16 v[88:91], a[136:139], v[96:103], v36
  v_cndmask_b32_dpp v234, v238, v242, vcc quad_perm:[1,0,3,2] row_mask:0xf bank_mask:0xf
  v_cndmask_b32_dpp v235, v239, v243, vcc quad_perm:[1,0,3,2] row_mask:0xf bank_mask:0xf
  buffer_store_dwordx4 v[232:235], v7, s[20:23], s37 offen offset:2048 nt
  v_smfmac_f32_16x16x64_bf16 v[92:95], a[140:143], v[96:103], v44
  s_add_u32 s41, s41, 32768
  s_and_b32 s41, s41, 0x7ffff
  s_add_u32 s37, s41, s42
  s_waitcnt lgkmcnt(12)
  v_smfmac_f32_16x16x64_bf16 v[80:83], a[144:147], v[104:111], v20 abid:1
  s_waitcnt lgkmcnt(2)
  v_lshl_or_b32 v224, v225, 16, v224
  v_lshl_or_b32 v226, v227, 16, v226
  v_smfmac_f32_16x16x64_bf16 v[84:87], a[148:151], v[104:111], v28 abid:1
  v_lshl_or_b32 v228, v229, 16, v228
  v_lshl_or_b32 v230, v231, 16, v230
  ds_read_b128 v[96:99], v8 offset:7680
  v_smfmac_f32_16x16x64_bf16 v[88:91], a[152:155], v[104:111], v36 abid:1
  ds_read_b128 v[100:103], v9 offset:7680
  ds_read_u16 v244, v216 offset:6144
  ds_read_u16 v245, v217 offset:6144
  v_smfmac_f32_16x16x64_bf16 v[92:95], a[156:159], v[104:111], v44 abid:1
  ds_read_u16 v246, v218 offset:6144
  ds_read_u16 v247, v219 offset:6144
  v_smfmac_f32_16x16x64_bf16 v[80:83], v[160:163], v[224:231], v253
  v_smfmac_f32_16x16x64_bf16 v[84:87], v[164:167], v[224:231], v253
  v_smfmac_f32_16x16x64_bf16 v[88:91], v[168:171], v[224:231], v253
  v_smfmac_f32_16x16x64_bf16 v[92:95], v[172:175], v[224:231], v253
  s_waitcnt lgkmcnt(12)
  v_smfmac_f32_16x16x64_bf16 v[80:83], a[160:163], v[112:119], v21
  ds_read_b128 v[104:107], v10 offset:7680
  ds_read_b128 v[108:111], v11 offset:7680
  v_smfmac_f32_16x16x64_bf16 v[84:87], a[164:167], v[112:119], v29
  ds_read_u16 v248, v220 offset:6144
  ds_read_u16 v249, v221 offset:6144
  v_smfmac_f32_16x16x64_bf16 v[88:91], a[168:171], v[112:119], v37
  ds_read_u16 v250, v222 offset:6144
  v_smfmac_f32_16x16x64_bf16 v[92:95], a[172:175], v[112:119], v45
  ds_read_u16 v251, v223 offset:6144
  s_waitcnt lgkmcnt(12)
  v_smfmac_f32_16x16x64_bf16 v[80:83], a[176:179], v[120:127], v21 abid:1
  ds_read_b128 v[112:115], v8 offset:7936
  ds_read_b128 v[116:119], v9 offset:7936
  v_mov_b32 v64, v48
  v_smfmac_f32_16x16x64_bf16 v[84:87], a[180:183], v[120:127], v29 abid:1
  v_mov_b32 v65, v49
  v_mov_b32 v66, v50
  v_mov_b32 v67, v51
  v_smfmac_f32_16x16x64_bf16 v[88:91], a[184:187], v[120:127], v37 abid:1
  v_mov_b32 v68, v52
  v_mov_b32 v69, v53
  v_smfmac_f32_16x16x64_bf16 v[92:95], a[188:191], v[120:127], v45 abid:1
  v_mov_b32 v70, v54
  v_mov_b32 v71, v55
  s_waitcnt lgkmcnt(12)
  v_smfmac_f32_16x16x64_bf16 v[80:83], a[192:195], v[96:103], v22
  s_waitcnt lgkmcnt(2)
  v_lshl_or_b32 v244, v245, 16, v244
  v_smfmac_f32_16x16x64_bf16 v[84:87], a[196:199], v[96:103], v30
  v_lshl_or_b32 v246, v247, 16, v246
  v_lshl_or_b32 v248, v249, 16, v248
  v_smfmac_f32_16x16x64_bf16 v[88:91], a[200:203], v[96:103], v38
  v_lshl_or_b32 v250, v251, 16, v250
  ds_read_b128 v[120:123], v10 offset:7936
  v_smfmac_f32_16x16x64_bf16 v[92:95], a[204:207], v[96:103], v46
  ds_read_b128 v[124:127], v11 offset:7936
  v_smfmac_f32_16x16x64_bf16 v[80:83], v[176:179], v[244:251], v253
  v_smfmac_f32_16x16x64_bf16 v[84:87], v[180:183], v[244:251], v253
  v_smfmac_f32_16x16x64_bf16 v[88:91], v[184:187], v[244:251], v253
  v_smfmac_f32_16x16x64_bf16 v[92:95], v[188:191], v[244:251], v253
  s_cmp_gt_u32 s39, 4
  s_cbranch_scc1 Lslow_b2
Lslowback_b2:
  s_waitcnt vmcnt(20)
  s_barrier
  s_waitcnt lgkmcnt(8)
  v_smfmac_f32_16x16x64_bf16 v[80:83], a[208:211], v[104:111], v22 abid:1
  ds_read_b128 v[96:99], v8 offset:8192
  ds_read_b128 v[100:103], v9 offset:8192
  v_smfmac_f32_16x16x64_bf16 v[84:87], a[212:215], v[104:111], v30 abid:1
  s_add_u32 m0, s60, 4096
  v_smfmac_f32_16x16x64_bf16 v[88:91], a[216:219], v[104:111], v38 abid:1
  s_nop 0
  v_smfmac_f32_16x16x64_bf16 v[92:95], a[220:223], v[104:111], v46 abid:1
  buffer_load_dwordx4 v3, s[16:19], s36 offen offset:0 nt lds
  s_waitcnt lgkmcnt(4)
  v_smfmac_f32_16x16x64_bf16 v[80:83], a[224:227], v[112:119], v23
  ds_read_b128 v[104:107], v10 offset:8192
  ds_read_b128 v[108:111], v11 offset:8192
  v_mov_b32 v72, v56
  v_smfmac_f32_16x16x64_bf16 v[84:87], a[228:231], v[112:119], v31
  v_mov_b32 v73, v57
  v_mov_b32 v74, v58
  v_mov_b32 v75, v59
  v_smfmac_f32_16x16x64_bf16 v[88:91], a[232:235], v[112:119], v39
  v_mov_b32 v76, v60
  v_mov_b32 v77, v61
  v_mov_b32 v78, v62
  v_smfmac_f32_16x16x64_bf16 v[92:95], a[236:239], v[112:119], v47
  v_mov_b32 v79, v63
  buffer_load_dwordx4 v3, s[16:19], s36 offen offset:1024 nt lds
  s_waitcnt lgkmcnt(4)
  v_smfmac_f32_16x16x64_bf16 v[80:83], a[240:243], v[120:127], v23 abid:1
  ds_read_b128 v[112:115], v8 offset:8448
  ds_read_b128 v[116:119], v9 offset:8448
  v_smfmac_f32_16x16x64_bf16 v[84:87], a[244:247], v[120:127], v31 abid:1
  s_add_u32 m0, s61, 4096
  v_smfmac_f32_16x16x64_bf16 v[88:91], a[248:251], v[120:127], v39 abid:1
  s_nop 0
  v_smfmac_f32_16x16x64_bf16 v[92:95], a[252:255], v[120:127], v47 abid:1
  buffer_load_dwordx4 v4, s[16:19], s36 offen offset:0 nt lds
  s_waitcnt lgkmcnt(4)
  v_smfmac_f32_16x16x64_bf16 v[64:67], a[0:3], v[96:103], v16
  ds_read_b128 v[120:123], v10 offset:8448
  ds_read_b128 v[124:127], v11 offset:8448
  v_smfmac_f32_16x16x64_bf16 v[68:71], a[4:7], v[96:103], v24
  buffer_load_dwordx4 v4, s[16:19], s36 offen offset:1024 nt lds
  ds_read_u16 v224, v192 offset:8192
  v_smfmac_f32_16x16x64_bf16 v[72:75], a[8:11], v[96:103], v32
  ds_read_u16 v225, v193 offset:8192
  ds_read_u16 v226, v194 offset:8192
  v_smfmac_f32_16x16x64_bf16 v[76:79], a[12:15], v[96:103], v40
  ds_read_u16 v227, v195 offset:8192
  s_waitcnt lgkmcnt(8)
  v_smfmac_f32_16x16x64_bf16 v[64:67], a[16:19], v[104:111], v16 abid:1
  ds_read_b128 v[96:99], v8 offset:8704
  ds_read_b128 v[100:103], v9 offset:8704
  s_add_u32 m0, s62, 4096
  v_smfmac_f32_16x16x64_bf16 v[68:71], a[20:23], v[104:111], v24 abid:1
  s_nop 0
  buffer_load_dwordx4 v5, s[16:19], s36 offen offset:0 nt lds
  v_smfmac_f32_16x16x64_bf16 v[72:75], a[24:27], v[104:111], v32 abid:1
  ds_read_u16 v228, v196 offset:8192
  ds_read_u16 v229, v197 offset:8192
  v_smfmac_f32_16x16x64_bf16 v[76:79], a[28:31], v[104:111], v40 abid:1
  ds_read_u16 v230, v198 offset:8192
  ds_read_u16 v231, v199 offset:8192
  s_waitcnt lgkmcnt(12)
  v_smfmac_f32_16x16x64_bf16 v[64:67], a[32:35], v[112:119], v17
  ds_read_b128 v[104:107], v10 offset:8704
  v_smfmac_f32_16x16x64_bf16 v[68:71], a[36:39], v[112:119], v25
  ds_read_b128 v[108:111], v11 offset:8704
  v_smfmac_f32_16x16x64_bf16 v[72:75], a[40:43], v[112:119], v33
  buffer_load_dwordx4 v5, s[16:19], s36 offen offset:1024 nt lds
  v_smfmac_f32_16x16x64_bf16 v[76:79], a[44:47], v[112:119], v41
  s_waitcnt lgkmcnt(12)
  v_smfmac_f32_16x16x64_bf16 v[64:67], a[48:51], v[120:127], v17 abid:1
  s_waitcnt lgkmcnt(2)
  v_lshl_or_b32 v224, v225, 16, v224
  v_lshl_or_b32 v226, v227, 16, v226
  v_lshl_or_b32 v228, v229, 16, v228
  v_smfmac_f32_16x16x64_bf16 v[68:71], a[52:55], v[120:127], v25 abid:1
  v_lshl_or_b32 v230, v231, 16, v230
  ds_read_b128 v[112:115], v8 offset:8960
  ds_read_b128 v[116:119], v9 offset:8960
  s_add_u32 m0, s63, 4096
  v_smfmac_f32_16x16x64_bf16 v[72:75], a[56:59], v[120:127], v33 abid:1
  s_nop 0
  buffer_load_dwordx4 v6, s[16:19], s36 offen offset:0 nt lds
  ds_read_u16 v244, v200 offset:8192
  v_smfmac_f32_16x16x64_bf16 v[76:79], a[60:63], v[120:127], v41 abid:1
  ds_read_u16 v245, v201 offset:8192
  ds_read_u16 v246, v202 offset:8192
  ds_read_u16 v247, v203 offset:8192
  v_smfmac_f32_16x16x64_bf16 v[64:67], v[128:131], v[224:231], v253
  v_smfmac_f32_16x16x64_bf16 v[68:71], v[132:135], v[224:231], v253
  v_smfmac_f32_16x16x64_bf16 v[72:75], v[136:139], v[224:231], v253
  v_smfmac_f32_16x16x64_bf16 v[76:79], v[140:143], v[224:231], v253
  s_waitcnt lgkmcnt(12)
  v_smfmac_f32_16x16x64_bf16 v[64:67], a[64:67], v[96:103], v18
  ds_read_b128 v[120:123], v10 offset:8960
  ds_read_b128 v[124:127], v11 offset:8960
  v_cvt_pk_bf16_f32 v236, v80, v81
  v_cvt_pk_bf16_f32 v237, v82, v83
  v_cvt_pk_bf16_f32 v238, v84, v85
  v_cvt_pk_bf16_f32 v239, v86, v87
  v_smfmac_f32_16x16x64_bf16 v[68:71], a[68:71], v[96:103], v26
  v_cvt_pk_bf16_f32 v240, v88, v89
  v_cvt_pk_bf16_f32 v241, v90, v91
  v_cvt_pk_bf16_f32 v242, v92, v93
  v_cvt_pk_bf16_f32 v243, v94, v95
  buffer_load_dwordx4 v6, s[16:19], s36 offen offset:1024 nt lds
  v_smfmac_f32_16x16x64_bf16 v[72:75], a[72:75], v[96:103], v34
  s_add_u32 s59, s59, 1
  s_add_u32 s40, s40, 32768
  s_and_b32 s40, s40, 0x7ffff
  s_add_u32 s36, s40, s56
  s_cmp_ge_u32 s59, 16
  v_smfmac_f32_16x16x64_bf16 v[76:79], a[76:79], v[96:103], v42
  s_cselect_b32 s36, 1073741824, s36
  ds_read_u16 v248, v204 offset:8192
  ds_read_u16 v249, v205 offset:8192
  ds_read_u16 v250, v206 offset:8192
  ds_read_u16 v251, v207 offset:8192
  s_waitcnt lgkmcnt(12)
  v_smfmac_f32_16x16x64_bf16 v[64:67], a[80:83], v[104:111], v18 abid:1
  ds_read_b128 v[96:99], v8 offset:9216
  ds_read_b128 v[100:103], v9 offset:9216
  v_smfmac_f32_16x16x64_bf16 v[68:71], a[84:87], v[104:111], v26 abid:1
  s_mov_b64 vcc, s[48:49]
  v_cndmask_b32_dpp v232, v240, v236, vcc quad_perm:[1,0,3,2] row_mask:0xf bank_mask:0xf
  v_smfmac_f32_16x16x64_bf16 v[72:75], a[88:91], v[104:111], v34 abid:1
  v_cndmask_b32_dpp v233, v241, v237, vcc quad_perm:[1,0,3,2] row_mask:0xf bank_mask:0xf
  v_cndmask_b32_dpp v234, v242, v238, vcc quad_perm:[1,0,3,2] row_mask:0xf bank_mask:0xf
  v_smfmac_f32_16x16x64_bf16 v[76:79], a[92:95], v[104:111], v42 abid:1
  v_cndmask_b32_dpp v235, v243, v239, vcc quad_perm:[1,0,3,2] row_mask:0xf bank_mask:0xf
  buffer_store_dwordx4 v[232:235], v7, s[20:23], s37 offen nt
  s_waitcnt lgkmcnt(12)
  v_smfmac_f32_16x16x64_bf16 v[64:67], a[96:99], v[112:119], v19
  s_waitcnt lgkmcnt(2)
  v_lshl_or_b32 v244, v245, 16, v244
  v_lshl_or_b32 v246, v247, 16, v246
  v_smfmac_f32_16x16x64_bf16 v[68:71], a[100:103], v[112:119], v27
  v_lshl_or_b32 v248, v249, 16, v248
  v_lshl_or_b32 v250, v251, 16, v250
  ds_read_b128 v[104:107], v10 offset:9216
  v_smfmac_f32_16x16x64_bf16 v[72:75], a[104:107], v[112:119], v35
  ds_read_b128 v[108:111], v11 offset:9216
  ds_read_u16 v224, v208 offset:8192
  ds_read_u16 v225, v209 offset:8192
  v_smfmac_f32_16x16x64_bf16 v[76:79], a[108:111], v[112:119], v43
  ds_read_u16 v226, v210 offset:8192
  ds_read_u16 v227, v211 offset:8192
  v_smfmac_f32_16x16x64_bf16 v[64:67], v[144:147], v[244:251], v253
  v_smfmac_f32_16x16x64_bf16 v[68:71], v[148:151], v[244:251], v253
  v_smfmac_f32_16x16x64_bf16 v[72:75], v[152:155], v[244:251], v253
  v_smfmac_f32_16x16x64_bf16 v[76:79], v[156:159], v[244:251], v253
  s_waitcnt lgkmcnt(12)
  v_smfmac_f32_16x16x64_bf16 v[64:67], a[112:115], v[120:127], v19 abid:1
  ds_read_b128 v[112:115], v8 offset:9472
  ds_read_b128 v[116:119], v9 offset:9472
  v_smfmac_f32_16x16x64_bf16 v[68:71], a[116:119], v[120:127], v27 abid:1
  ds_read_u16 v228, v212 offset:8192
  ds_read_u16 v229, v213 offset:8192
  v_smfmac_f32_16x16x64_bf16 v[72:75], a[120:123], v[120:127], v35 abid:1
  ds_read_u16 v230, v214 offset:8192
  v_smfmac_f32_16x16x64_bf16 v[76:79], a[124:127], v[120:127], v43 abid:1
  ds_read_u16 v231, v215 offset:8192
  s_waitcnt lgkmcnt(12)
  v_smfmac_f32_16x16x64_bf16 v[64:67], a[128:131], v[96:103], v20
  ds_read_b128 v[120:123], v10 offset:9472
  ds_read_b128 v[124:127], v11 offset:9472
  s_not_b64 vcc, s[48:49]
  v_smfmac_f32_16x16x64_bf16 v[68:71], a[132:135], v[96:103], v28
  s_nop 0
  v_cndmask_b32_dpp v232, v236, v240, vcc quad_perm:[1,0,3,2] row_mask:0xf bank_mask:0xf
  v_cndmask_b32_dpp v233, v237, v241, vcc quad_perm:[1,0,3,2] row_mask:0xf bank_mask:0xf
  v_smfmac_f32_16x16x64_bf16 v[72:75], a[136:139], v[96:103], v36
  v_cndmask_b32_dpp v234, v238, v242, vcc quad_perm:[1,0,3,2] row_mask:0xf bank_mask:0xf
  v_cndmask_b32_dpp v235, v239, v243, vcc quad_perm:[1,0,3,2] row_mask:0xf bank_mask:0xf
  buffer_store_dwordx4 v[232:235], v7, s[20:23], s37 offen offset:2048 nt
  v_smfmac_f32_16x16x64_bf16 v[76:79], a[140:143], v[96:103], v44
  s_add_u32 s41, s41, 32768
  s_and_b32 s41, s41, 0x7ffff
  s_add_u32 s37, s41, s42
  s_waitcnt lgkmcnt(12)
  v_smfmac_f32_16x16x64_bf16 v[64:67], a[144:147], v[104:111], v20 abid:1
  s_waitcnt lgkmcnt(2)
  v_lshl_or_b32 v224, v225, 16, v224
  v_lshl_or_b32 v226, v227, 16, v226
  v_smfmac_f32_16x16x64_bf16 v[68:71], a[148:151], v[104:111], v28 abid:1
  v_lshl_or_b32 v228, v229, 16, v228
  v_lshl_or_b32 v230, v231, 16, v230
  ds_read_b128 v[96:99], v8 offset:9728
  v_smfmac_f32_16x16x64_bf16 v[72:75], a[152:155], v[104:111], v36 abid:1
  ds_read_b128 v[100:103], v9 offset:9728
  ds_read_u16 v244, v216 offset:8192
  ds_read_u16 v245, v217 offset:8192
  v_smfmac_f32_16x16x64_bf16 v[76:79], a[156:159], v[104:111], v44 abid:1
  ds_read_u16 v246, v218 offset:8192
  ds_read_u16 v247, v219 offset:8192
  v_smfmac_f32_16x16x64_bf16 v[64:67], v[160:163], v[224:231], v253
  v_smfmac_f32_16x16x64_bf16 v[68:71], v[164:167], v[224:231], v253
  v_smfmac_f32_16x16x64_bf16 v[72:75], v[168:171], v[224:231], v253
  v_smfmac_f32_16x16x64_bf16 v[76:79], v[172:175], v[224:231], v253
  s_waitcnt lgkmcnt(12)
  v_smfmac_f32_16x16x64_bf16 v[64:67], a[160:163], v[112:119], v21
  ds_read_b128 v[104:107], v10 offset:9728
  ds_read_b128 v[108:111], v11 offset:9728
  v_smfmac_f32_16x16x64_bf16 v[68:71], a[164:167], v[112:119], v29
  ds_read_u16 v248, v220 offset:8192
  ds_read_u16 v249, v221 offset:8192
  v_smfmac_f32_16x16x64_bf16 v[72:75], a[168:171], v[112:119], v37
  ds_read_u16 v250, v222 offset:8192
  v_smfmac_f32_16x16x64_bf16 v[76:79], a[172:175], v[112:119], v45
  ds_read_u16 v251, v223 offset:8192
  s_waitcnt lgkmcnt(12)
  v_smfmac_f32_16x16x64_bf16 v[64:67], a[176:179], v[120:127], v21 abid:1
  ds_read_b128 v[112:115], v8 offset:9984
  ds_read_b128 v[116:119], v9 offset:9984
  v_mov_b32 v80, v48
  v_smfmac_f32_16x16x64_bf16 v[68:71], a[180:183], v[120:127], v29 abid:1
  v_mov_b32 v81, v49
  v_mov_b32 v82, v50
  v_mov_b32 v83, v51
  v_smfmac_f32_16x16x64_bf16 v[72:75], a[184:187], v[120:127], v37 abid:1
  v_mov_b32 v84, v52
  v_mov_b32 v85, v53
  v_smfmac_f32_16x16x64_bf16 v[76:79], a[188:191], v[120:127], v45 abid:1
  v_mov_b32 v86, v54
  v_mov_b32 v87, v55
  s_waitcnt lgkmcnt(12)
  v_smfmac_f32_16x16x64_bf16 v[64:67], a[192:195], v[96:103], v22
  s_waitcnt lgkmcnt(2)
  v_lshl_or_b32 v244, v245, 16, v244
  v_smfmac_f32_16x16x64_bf16 v[68:71], a[196:199], v[96:103], v30
  v_lshl_or_b32 v246, v247, 16, v246
  v_lshl_or_b32 v248, v249, 16, v248
  v_smfmac_f32_16x16x64_bf16 v[72:75], a[200:203], v[96:103], v38
  v_lshl_or_b32 v250, v251, 16, v250
  ds_read_b128 v[120:123], v10 offset:9984
  v_smfmac_f32_16x16x64_bf16 v[76:79], a[204:207], v[96:103], v46
  ds_read_b128 v[124:127], v11 offset:9984
  v_smfmac_f32_16x16x64_bf16 v[64:67], v[176:179], v[244:251], v253
  v_smfmac_f32_16x16x64_bf16 v[68:71], v[180:183], v[244:251], v253
  v_smfmac_f32_16x16x64_bf16 v[72:75], v[184:187], v[244:251], v253
  v_smfmac_f32_16x16x64_bf16 v[76:79], v[188:191], v[244:251], v253
  s_cmp_gt_u32 s39, 4
  s_cbranch_scc1 Lslow_b3
Lslowback_b3:
  s_waitcnt vmcnt(22)
  s_barrier
  s_waitcnt lgkmcnt(8)
  v_smfmac_f32_16x16x64_bf16 v[64:67], a[208:211], v[104:111], v22 abid:1
  ds_read_b128 v[96:99], v8 offset:0
  ds_read_b128 v[100:103], v9 offset:0
  v_smfmac_f32_16x16x64_bf16 v[68:71], a[212:215], v[104:111], v30 abid:1
  s_add_u32 m0, s60, 6144
  v_smfmac_f32_16x16x64_bf16 v[72:75], a[216:219], v[104:111], v38 abid:1
  s_nop 0
  v_smfmac_f32_16x16x64_bf16 v[76:79], a[220:223], v[104:111], v46 abid:1
  buffer_load_dwordx4 v3, s[16:19], s36 offen offset:0 nt lds
  s_waitcnt lgkmcnt(4)
  v_smfmac_f32_16x16x64_bf16 v[64:67], a[224:227], v[112:119], v23
  ds_read_b128 v[104:107], v10 offset:0
  ds_read_b128 v[108:111], v11 offset:0
  v_mov_b32 v88, v56
  v_smfmac_f32_16x16x64_bf16 v[68:71], a[228:231], v[112:119], v31
  v_mov_b32 v89, v57
  v_mov_b32 v90, v58
  v_mov_b32 v91, v59
  v_smfmac_f32_16x16x64_bf16 v[72:75], a[232:235], v[112:119], v39
  v_mov_b32 v92, v60
  v_mov_b32 v93, v61
  v_mov_b32 v94, v62
  v_smfmac_f32_16x16x64_bf16 v[76:79], a[236:239], v[112:119], v47
  v_mov_b32 v95, v63
  buffer_load_dwordx4 v3, s[16:19], s36 offen offset:1024 nt lds
  s_waitcnt lgkmcnt(4)
  v_smfmac_f32_16x16x64_bf16 v[64:67], a[240:243], v[120:127], v23 abid:1
  ds_read_b128 v[112:115], v8 offset:256
  ds_read_b128 v[116:119], v9 offset:256
  v_smfmac_f32_16x16x64_bf16 v[68:71], a[244:247], v[120:127], v31 abid:1
  s_add_u32 m0, s61, 6144
  v_smfmac_f32_16x16x64_bf16 v[72:75], a[248:251], v[120:127], v39 abid:1
  s_nop 0
  v_smfmac_f32_16x16x64_bf16 v[76:79], a[252:255], v[120:127], v47 abid:1
  buffer_load_dwordx4 v4, s[16:19], s36 offen offset:0 nt lds
  s_waitcnt lgkmcnt(4)
  v_smfmac_f32_16x16x64_bf16 v[80:83], a[0:3], v[96:103], v16
  ds_read_b128 v[120:123], v10 offset:256
  ds_read_b128 v[124:127], v11 offset:256
  v_smfmac_f32_16x16x64_bf16 v[84:87], a[4:7], v[96:103], v24
  buffer_load_dwordx4 v4, s[16:19], s36 offen offset:1024 nt lds
  ds_read_u16 v224, v192 offset:0
  v_smfmac_f32_16x16x64_bf16 v[88:91], a[8:11], v[96:103], v32
  ds_read_u16 v225, v193 offset:0
  ds_read_u16 v226, v194 offset:0
  v_smfmac_f32_16x16x64_bf16 v[92:95], a[12:15], v[96:103], v40
  ds_read_u16 v227, v195 offset:0
  s_waitcnt lgkmcnt(8)
  v_smfmac_f32_16x16x64_bf16 v[80:83], a[16:19], v[104:111], v16 abid:1
  ds_read_b128 v[96:99], v8 offset:512
  ds_read_b128 v[100:103], v9 offset:512
  s_add_u32 m0, s62, 6144
  v_smfmac_f32_16x16x64_bf16 v[84:87], a[20:23], v[104:111], v24 abid:1
  s_nop 0
  buffer_load_dwordx4 v5, s[16:19], s36 offen offset:0 nt lds
  v_smfmac_f32_16x16x64_bf16 v[88:91], a[24:27], v[104:111], v32 abid:1
  ds_read_u16 v228, v196 offset:0
  ds_read_u16 v229, v197 offset:0
  v_smfmac_f32_16x16x64_bf16 v[92:95], a[28:31], v[104:111], v40 abid:1
  ds_read_u16 v230, v198 offset:0
  ds_read_u16 v231, v199 offset:0
  s_waitcnt lgkmcnt(12)
  v_smfmac_f32_16x16x64_bf16 v[80:83], a[32:35], v[112:119], v17
  ds_read_b128 v[104:107], v10 offset:512
  v_smfmac_f32_16x16x64_bf16 v[84:87], a[36:39], v[112:119], v25
  ds_read_b128 v[108:111], v11 offset:512
  v_smfmac_f32_16x16x64_bf16 v[88:91], a[40:43], v[112:119], v33
  buffer_load_dwordx4 v5, s[16:19], s36 offen offset:1024 nt lds
  v_smfmac_f32_16x16x64_bf16 v[92:95], a[44:47], v[112:119], v41
  s_waitcnt lgkmcnt(12)
  v_smfmac_f32_16x16x64_bf16 v[80:83], a[48:51], v[120:127], v17 abid:1
  s_waitcnt lgkmcnt(2)
  v_lshl_or_b32 v224, v225, 16, v224
  v_lshl_or_b32 v226, v227, 16, v226
  v_lshl_or_b32 v228, v229, 16, v228
  v_smfmac_f32_16x16x64_bf16 v[84:87], a[52:55], v[120:127], v25 abid:1
  v_lshl_or_b32 v230, v231, 16, v230
  ds_read_b128 v[112:115], v8 offset:768
  ds_read_b128 v[116:119], v9 offset:768
  s_add_u32 m0, s63, 6144
  v_smfmac_f32_16x16x64_bf16 v[88:91], a[56:59], v[120:127], v33 abid:1
  s_nop 0
  buffer_load_dwordx4 v6, s[16:19], s36 offen offset:0 nt lds
  ds_read_u16 v244, v200 offset:0
  v_smfmac_f32_16x16x64_bf16 v[92:95], a[60:63], v[120:127], v41 abid:1
  ds_read_u16 v245, v201 offset:0
  ds_read_u16 v246, v202 offset:0
  ds_read_u16 v247, v203 offset:0
  v_smfmac_f32_16x16x64_bf16 v[80:83], v[128:131], v[224:231], v253
  v_smfmac_f32_16x16x64_bf16 v[84:87], v[132:135], v[224:231], v253
  v_smfmac_f32_16x16x64_bf16 v[88:91], v[136:139], v[224:231], v253
  v_smfmac_f32_16x16x64_bf16 v[92:95], v[140:143], v[224:231], v253
  s_waitcnt lgkmcnt(12)
  v_smfmac_f32_16x16x64_bf16 v[80:83], a[64:67], v[96:103], v18
  ds_read_b128 v[120:123], v10 offset:768
  ds_read_b128 v[124:127], v11 offset:768
  v_cvt_pk_bf16_f32 v236, v64, v65
  v_cvt_pk_bf16_f32 v237, v66, v67
  v_cvt_pk_bf16_f32 v238, v68, v69
  v_cvt_pk_bf16_f32 v239, v70, v71
  v_smfmac_f32_16x16x64_bf16 v[84:87], a[68:71], v[96:103], v26
  v_cvt_pk_bf16_f32 v240, v72, v73
  v_cvt_pk_bf16_f32 v241, v74, v75
  v_cvt_pk_bf16_f32 v242, v76, v77
  v_cvt_pk_bf16_f32 v243, v78, v79
  buffer_load_dwordx4 v6, s[16:19], s36 offen offset:1024 nt lds
  v_smfmac_f32_16x16x64_bf16 v[88:91], a[72:75], v[96:103], v34
  s_add_u32 s59, s59, 1
  s_add_u32 s40, s40, 32768
  s_and_b32 s40, s40, 0x7ffff
  s_add_u32 s36, s40, s56
  s_cmp_ge_u32 s59, 16
  v_smfmac_f32_16x16x64_bf16 v[92:95], a[76:79], v[96:103], v42
  s_cselect_b32 s36, 1073741824, s36
  ds_read_u16 v248, v204 offset:0
  ds_read_u16 v249, v205 offset:0
  ds_read_u16 v250, v206 offset:0
  ds_read_u16 v251, v207 offset:0
  s_waitcnt lgkmcnt(12)
  v_smfmac_f32_16x16x64_bf16 v[80:83], a[80:83], v[104:111], v18 abid:1
  ds_read_b128 v[96:99], v8 offset:1024
  ds_read_b128 v[100:103], v9 offset:1024
  v_smfmac_f32_16x16x64_bf16 v[84:87], a[84:87], v[104:111], v26 abid:1
  s_mov_b64 vcc, s[48:49]
  v_cndmask_b32_dpp v232, v240, v236, vcc quad_perm:[1,0,3,2] row_mask:0xf bank_mask:0xf
  v_smfmac_f32_16x16x64_bf16 v[88:91], a[88:91], v[104:111], v34 abid:1
  v_cndmask_b32_dpp v233, v241, v237, vcc quad_perm:[1,0,3,2] row_mask:0xf bank_mask:0xf
  v_cndmask_b32_dpp v234, v242, v238, vcc quad_perm:[1,0,3,2] row_mask:0xf bank_mask:0xf
  v_smfmac_f32_16x16x64_bf16 v[92:95], a[92:95], v[104:111], v42 abid:1
  v_cndmask_b32_dpp v235, v243, v239, vcc quad_perm:[1,0,3,2] row_mask:0xf bank_mask:0xf
  buffer_store_dwordx4 v[232:235], v7, s[20:23], s37 offen nt
  s_waitcnt lgkmcnt(12)
  v_smfmac_f32_16x16x64_bf16 v[80:83], a[96:99], v[112:119], v19
  s_waitcnt lgkmcnt(2)
  v_lshl_or_b32 v244, v245, 16, v244
  v_lshl_or_b32 v246, v247, 16, v246
  v_smfmac_f32_16x16x64_bf16 v[84:87], a[100:103], v[112:119], v27
  v_lshl_or_b32 v248, v249, 16, v248
  v_lshl_or_b32 v250, v251, 16, v250
  ds_read_b128 v[104:107], v10 offset:1024
  v_smfmac_f32_16x16x64_bf16 v[88:91], a[104:107], v[112:119], v35
  ds_read_b128 v[108:111], v11 offset:1024
  ds_read_u16 v224, v208 offset:0
  ds_read_u16 v225, v209 offset:0
  v_smfmac_f32_16x16x64_bf16 v[92:95], a[108:111], v[112:119], v43
  ds_read_u16 v226, v210 offset:0
  ds_read_u16 v227, v211 offset:0
  v_smfmac_f32_16x16x64_bf16 v[80:83], v[144:147], v[244:251], v253
  v_smfmac_f32_16x16x64_bf16 v[84:87], v[148:151], v[244:251], v253
  v_smfmac_f32_16x16x64_bf16 v[88:91], v[152:155], v[244:251], v253
  v_smfmac_f32_16x16x64_bf16 v[92:95], v[156:159], v[244:251], v253
  s_waitcnt lgkmcnt(12)
  v_smfmac_f32_16x16x64_bf16 v[80:83], a[112:115], v[120:127], v19 abid:1
  ds_read_b128 v[112:115], v8 offset:1280
  ds_read_b128 v[116:119], v9 offset:1280
  v_smfmac_f32_16x16x64_bf16 v[84:87], a[116:119], v[120:127], v27 abid:1
  ds_read_u16 v228, v212 offset:0
  ds_read_u16 v229, v213 offset:0
  v_smfmac_f32_16x16x64_bf16 v[88:91], a[120:123], v[120:127], v35 abid:1
  ds_read_u16 v230, v214 offset:0
  v_smfmac_f32_16x16x64_bf16 v[92:95], a[124:127], v[120:127], v43 abid:1
  ds_read_u16 v231, v215 offset:0
  s_waitcnt lgkmcnt(12)
  v_smfmac_f32_16x16x64_bf16 v[80:83], a[128:131], v[96:103], v20
  ds_read_b128 v[120:123], v10 offset:1280
  ds_read_b128 v[124:127], v11 offset:1280
  s_not_b64 vcc, s[48:49]
  v_smfmac_f32_16x16x64_bf16 v[84:87], a[132:135], v[96:103], v28
  s_nop 0
  v_cndmask_b32_dpp v232, v236, v240, vcc quad_perm:[1,0,3,2] row_mask:0xf bank_mask:0xf
  v_cndmask_b32_dpp v233, v237, v241, vcc quad_perm:[1,0,3,2] row_mask:0xf bank_mask:0xf
  v_smfmac_f32_16x16x64_bf16 v[88:91], a[136:139], v[96:103], v36
  v_cndmask_b32_dpp v234, v238, v242, vcc quad_perm:[1,0,3,2] row_mask:0xf bank_mask:0xf
  v_cndmask_b32_dpp v235, v239, v243, vcc quad_perm:[1,0,3,2] row_mask:0xf bank_mask:0xf
  buffer_store_dwordx4 v[232:235], v7, s[20:23], s37 offen offset:2048 nt
  v_smfmac_f32_16x16x64_bf16 v[92:95], a[140:143], v[96:103], v44
  s_add_u32 s41, s41, 32768
  s_and_b32 s41, s41, 0x7ffff
  s_add_u32 s37, s41, s42
  s_waitcnt lgkmcnt(12)
  v_smfmac_f32_16x16x64_bf16 v[80:83], a[144:147], v[104:111], v20 abid:1
  s_waitcnt lgkmcnt(2)
  v_lshl_or_b32 v224, v225, 16, v224
  v_lshl_or_b32 v226, v227, 16, v226
  v_smfmac_f32_16x16x64_bf16 v[84:87], a[148:151], v[104:111], v28 abid:1
  v_lshl_or_b32 v228, v229, 16, v228
  v_lshl_or_b32 v230, v231, 16, v230
  ds_read_b128 v[96:99], v8 offset:1536
  v_smfmac_f32_16x16x64_bf16 v[88:91], a[152:155], v[104:111], v36 abid:1
  ds_read_b128 v[100:103], v9 offset:1536
  ds_read_u16 v244, v216 offset:0
  ds_read_u16 v245, v217 offset:0
  v_smfmac_f32_16x16x64_bf16 v[92:95], a[156:159], v[104:111], v44 abid:1
  ds_read_u16 v246, v218 offset:0
  ds_read_u16 v247, v219 offset:0
  v_smfmac_f32_16x16x64_bf16 v[80:83], v[160:163], v[224:231], v253
  v_smfmac_f32_16x16x64_bf16 v[84:87], v[164:167], v[224:231], v253
  v_smfmac_f32_16x16x64_bf16 v[88:91], v[168:171], v[224:231], v253
  v_smfmac_f32_16x16x64_bf16 v[92:95], v[172:175], v[224:231], v253
  s_waitcnt lgkmcnt(12)
  v_smfmac_f32_16x16x64_bf16 v[80:83], a[160:163], v[112:119], v21
  ds_read_b128 v[104:107], v10 offset:1536
  ds_read_b128 v[108:111], v11 offset:1536
  v_smfmac_f32_16x16x64_bf16 v[84:87], a[164:167], v[112:119], v29
  ds_read_u16 v248, v220 offset:0
  ds_read_u16 v249, v221 offset:0
  v_smfmac_f32_16x16x64_bf16 v[88:91], a[168:171], v[112:119], v37
  ds_read_u16 v250, v222 offset:0
  v_smfmac_f32_16x16x64_bf16 v[92:95], a[172:175], v[112:119], v45
  ds_read_u16 v251, v223 offset:0
  s_waitcnt lgkmcnt(12)
  v_smfmac_f32_16x16x64_bf16 v[80:83], a[176:179], v[120:127], v21 abid:1
  ds_read_b128 v[112:115], v8 offset:1792
  ds_read_b128 v[116:119], v9 offset:1792
  v_mov_b32 v64, v48
  v_smfmac_f32_16x16x64_bf16 v[84:87], a[180:183], v[120:127], v29 abid:1
  v_mov_b32 v65, v49
  v_mov_b32 v66, v50
  v_mov_b32 v67, v51
  v_smfmac_f32_16x16x64_bf16 v[88:91], a[184:187], v[120:127], v37 abid:1
  v_mov_b32 v68, v52
  v_mov_b32 v69, v53
  v_smfmac_f32_16x16x64_bf16 v[92:95], a[188:191], v[120:127], v45 abid:1
  v_mov_b32 v70, v54
  v_mov_b32 v71, v55
  s_waitcnt lgkmcnt(12)
  v_smfmac_f32_16x16x64_bf16 v[80:83], a[192:195], v[96:103], v22
  s_waitcnt lgkmcnt(2)
  v_lshl_or_b32 v244, v245, 16, v244
  v_smfmac_f32_16x16x64_bf16 v[84:87], a[196:199], v[96:103], v30
  v_lshl_or_b32 v246, v247, 16, v246
  v_lshl_or_b32 v248, v249, 16, v248
  v_smfmac_f32_16x16x64_bf16 v[88:91], a[200:203], v[96:103], v38
  v_lshl_or_b32 v250, v251, 16, v250
  ds_read_b128 v[120:123], v10 offset:1792
  v_smfmac_f32_16x16x64_bf16 v[92:95], a[204:207], v[96:103], v46
  ds_read_b128 v[124:127], v11 offset:1792
  v_smfmac_f32_16x16x64_bf16 v[80:83], v[176:179], v[244:251], v253
  v_smfmac_f32_16x16x64_bf16 v[84:87], v[180:183], v[244:251], v253
  v_smfmac_f32_16x16x64_bf16 v[88:91], v[184:187], v[244:251], v253
  v_smfmac_f32_16x16x64_bf16 v[92:95], v[188:191], v[244:251], v253
  s_cmp_gt_u32 s39, 4
  s_cbranch_scc1 Lslow_b4
Lslowback_b4:
  s_waitcnt vmcnt(22)
  s_barrier
  s_waitcnt lgkmcnt(8)
  v_smfmac_f32_16x16x64_bf16 v[80:83], a[208:211], v[104:111], v22 abid:1
  ds_read_b128 v[96:99], v8 offset:2048
  ds_read_b128 v[100:103], v9 offset:2048
  v_smfmac_f32_16x16x64_bf16 v[84:87], a[212:215], v[104:111], v30 abid:1
  s_add_u32 m0, s60, 8192
  v_smfmac_f32_16x16x64_bf16 v[88:91], a[216:219], v[104:111], v38 abid:1
  s_nop 0
  v_smfmac_f32_16x16x64_bf16 v[92:95], a[220:223], v[104:111], v46 abid:1
  buffer_load_dwordx4 v3, s[16:19], s36 offen offset:0 nt lds
  s_waitcnt lgkmcnt(4)
  v_smfmac_f32_16x16x64_bf16 v[80:83], a[224:227], v[112:119], v23
  ds_read_b128 v[104:107], v10 offset:2048
  ds_read_b128 v[108:111], v11 offset:2048
  v_mov_b32 v72, v56
  v_smfmac_f32_16x16x64_bf16 v[84:87], a[228:231], v[112:119], v31
  v_mov_b32 v73, v57
  v_mov_b32 v74, v58
  v_mov_b32 v75, v59
  v_smfmac_f32_16x16x64_bf16 v[88:91], a[232:235], v[112:119], v39
  v_mov_b32 v76, v60
  v_mov_b32 v77, v61
  v_mov_b32 v78, v62
  v_smfmac_f32_16x16x64_bf16 v[92:95], a[236:239], v[112:119], v47
  v_mov_b32 v79, v63
  buffer_load_dwordx4 v3, s[16:19], s36 offen offset:1024 nt lds
  s_waitcnt lgkmcnt(4)
  v_smfmac_f32_16x16x64_bf16 v[80:83], a[240:243], v[120:127], v23 abid:1
  ds_read_b128 v[112:115], v8 offset:2304
  ds_read_b128 v[116:119], v9 offset:2304
  v_smfmac_f32_16x16x64_bf16 v[84:87], a[244:247], v[120:127], v31 abid:1
  s_add_u32 m0, s61, 8192
  v_smfmac_f32_16x16x64_bf16 v[88:91], a[248:251], v[120:127], v39 abid:1
  s_nop 0
  v_smfmac_f32_16x16x64_bf16 v[92:95], a[252:255], v[120:127], v47 abid:1
  buffer_load_dwordx4 v4, s[16:19], s36 offen offset:0 nt lds
  s_nop 7
  v_cvt_pk_bf16_f32 v236, v80, v81
  v_cvt_pk_bf16_f32 v237, v82, v83
  v_cvt_pk_bf16_f32 v238, v84, v85
  v_cvt_pk_bf16_f32 v239, v86, v87
  v_cvt_pk_bf16_f32 v240, v88, v89
  v_cvt_pk_bf16_f32 v241, v90, v91
  v_cvt_pk_bf16_f32 v242, v92, v93
  v_cvt_pk_bf16_f32 v243, v94, v95
  s_nop 1
  s_mov_b64 vcc, s[48:49]
  v_cndmask_b32_dpp v232, v240, v236, vcc quad_perm:[1,0,3,2] row_mask:0xf bank_mask:0xf
  v_cndmask_b32_dpp v233, v241, v237, vcc quad_perm:[1,0,3,2] row_mask:0xf bank_mask:0xf
  v_cndmask_b32_dpp v234, v242, v238, vcc quad_perm:[1,0,3,2] row_mask:0xf bank_mask:0xf
  v_cndmask_b32_dpp v235, v243, v239, vcc quad_perm:[1,0,3,2] row_mask:0xf bank_mask:0xf
  buffer_store_dwordx4 v[232:235], v7, s[20:23], s37 offen nt
  s_not_b64 vcc, s[48:49]
  s_nop 0
  v_cndmask_b32_dpp v232, v236, v240, vcc quad_perm:[1,0,3,2] row_mask:0xf bank_mask:0xf
  v_cndmask_b32_dpp v233, v237, v241, vcc quad_perm:[1,0,3,2] row_mask:0xf bank_mask:0xf
  v_cndmask_b32_dpp v234, v238, v242, vcc quad_perm:[1,0,3,2] row_mask:0xf bank_mask:0xf
  v_cndmask_b32_dpp v235, v239, v243, vcc quad_perm:[1,0,3,2] row_mask:0xf bank_mask:0xf
  buffer_store_dwordx4 v[232:235], v7, s[20:23], s37 offen offset:2048 nt
  s_add_u32 s41, s41, 32768
  s_and_b32 s41, s41, 0x7ffff
  s_add_u32 s37, s41, s42
  v_mov_b32 v80, v48
  v_mov_b32 v81, v49
  v_mov_b32 v82, v50
  v_mov_b32 v83, v51
  v_mov_b32 v84, v52
  v_mov_b32 v85, v53
  v_mov_b32 v86, v54
  v_mov_b32 v87, v55
  v_mov_b32 v88, v56
  v_mov_b32 v89, v57
  v_mov_b32 v90, v58
  v_mov_b32 v91, v59
  v_mov_b32 v92, v60
  v_mov_b32 v93, v61
  v_mov_b32 v94, v62
  v_mov_b32 v95, v63
  s_nop 1
  s_add_u32 s38, s38, 1
  s_cmp_lt_u32 s38, 3
  s_cbranch_scc1 Lloop
Lm_end:
  s_endpgm
Lslow_f:
  s_mov_b32 s57, 4
Lslowloop_f:
  v_mbcnt_lo_u32_b32 v13, -1, 0
  v_mbcnt_hi_u32_b32 v13, -1, v13
  s_lshl_b32 s52, s57, 4
  v_add_u32 v13, s52, v13
  v_lshlrev_b32 v254, 4, v13
  s_mov_b32 s44, -1
  s_add_u32 s44, s44, s80
  s_lshl_b32 s45, s80, 4
  s_sub_u32 s45, 16384, s45
  v_sub_u32 v15, s44, v13
  v_ashrrev_i32 v15, 31, v15
  v_and_b32 v15, s45, v15
  v_add_u32 v254, v254, v15
  s_add_u32 s44, s44, s81
  s_lshl_b32 s45, s81, 4
  s_sub_u32 s45, 16384, s45
  v_sub_u32 v15, s44, v13
  v_ashrrev_i32 v15, 31, v15
  v_and_b32 v15, s45, v15
  v_add_u32 v254, v254, v15
  s_add_u32 s44, s44, s82
  s_lshl_b32 s45, s82, 4
  s_sub_u32 s45, 16384, s45
  v_sub_u32 v15, s44, v13
  v_ashrrev_i32 v15, 31, v15
  v_and_b32 v15, s45, v15
  v_add_u32 v254, v254, v15
  s_add_u32 s44, s44, s83
  s_lshl_b32 s45, s83, 4
  s_sub_u32 s45, 16384, s45
  v_sub_u32 v15, s44, v13
  v_ashrrev_i32 v15, 31, v15
  v_and_b32 v15, s45, v15
  v_add_u32 v254, v254, v15
  s_add_u32 s44, s44, s84
  s_lshl_b32 s45, s84, 4
  s_sub_u32 s45, 16384, s45
  v_sub_u32 v15, s44, v13
  v_ashrrev_i32 v15, 31, v15
  v_and_b32 v15, s45, v15
  v_add_u32 v254, v254, v15
  s_add_u32 s44, s44, s85
  s_lshl_b32 s45, s85, 4
  s_sub_u32 s45, 16384, s45
  v_sub_u32 v15, s44, v13
  v_ashrrev_i32 v15, 31, v15
  v_and_b32 v15, s45, v15
  v_add_u32 v254, v254, v15
  s_add_u32 s44, s44, s86
  s_lshl_b32 s45, s86, 4
  s_sub_u32 s45, 16384, s45
  v_sub_u32 v15, s44, v13
  v_ashrrev_i32 v15, 31, v15
  v_and_b32 v15, s45, v15
  v_add_u32 v254, v254, v15
  s_add_u32 s44, s44, s87
  s_lshl_b32 s45, s87, 4
  s_sub_u32 s45, 16384, s45
  v_sub_u32 v15, s44, v13
  v_ashrrev_i32 v15, 31, v15
  v_and_b32 v15, s45, v15
  v_add_u32 v254, v254, v15
  s_add_u32 s44, s44, s88
  s_lshl_b32 s45, s88, 4
  s_sub_u32 s45, 16384, s45
  v_sub_u32 v15, s44, v13
  v_ashrrev_i32 v15, 31, v15
  v_and_b32 v15, s45, v15
  v_add_u32 v254, v254, v15
  s_add_u32 s44, s44, s89
  s_lshl_b32 s45, s89, 4
  s_sub_u32 s45, 16384, s45
  v_sub_u32 v15, s44, v13
  v_ashrrev_i32 v15, 31, v15
  v_and_b32 v15, s45, v15
  v_add_u32 v254, v254, v15
  s_add_u32 s44, s44, s90
  s_lshl_b32 s45, s90, 4
  s_sub_u32 s45, 16384, s45
  v_sub_u32 v15, s44, v13
  v_ashrrev_i32 v15, 31, v15
  v_and_b32 v15, s45, v15
  v_add_u32 v254, v254, v15
  s_add_u32 s44, s44, s91
  s_lshl_b32 s45, s91, 4
  s_sub_u32 s45, 16384, s45
  v_sub_u32 v15, s44, v13
  v_ashrrev_i32 v15, 31, v15
  v_and_b32 v15, s45, v15
  v_add_u32 v254, v254, v15
  s_add_u32 s44, s44, s92
  s_lshl_b32 s45, s92, 4
  s_sub_u32 s45, 16384, s45
  v_sub_u32 v15, s44, v13
  v_ashrrev_i32 v15, 31, v15
  v_and_b32 v15, s45, v15
  v_add_u32 v254, v254, v15
  s_add_u32 s44, s44, s93
  s_lshl_b32 s45, s93, 4
  s_sub_u32 s45, 16384, s45
  v_sub_u32 v15, s44, v13
  v_ashrrev_i32 v15, 31, v15
  v_and_b32 v15, s45, v15
  v_add_u32 v254, v254, v15
  s_add_u32 s44, s44, s94
  s_lshl_b32 s45, s94, 4
  s_sub_u32 s45, 16384, s45
  v_sub_u32 v15, s44, v13
  v_ashrrev_i32 v15, 31, v15
  v_and_b32 v15, s45, v15
  v_add_u32 v254, v254, v15
  s_add_u32 s44, s44, s95
  v_sub_u32 v15, s44, v13
  v_ashrrev_i32 v15, 31, v15
  v_and_b32 v15, 1073741824, v15
  v_or_b32 v254, v254, v15
  ds_bpermute_b32 v224, v252, v254 offset:0
  ds_bpermute_b32 v225, v252, v254 offset:4
  ds_bpermute_b32 v226, v252, v254 offset:8
  ds_bpermute_b32 v227, v252, v254 offset:12
  s_waitcnt lgkmcnt(0)
  buffer_load_dwordx2 v[236:237], v224, s[24:27], s51 offen
  buffer_load_dwordx2 v[244:245], v224, s[24:27], s51 offen offset:8
  buffer_load_dwordx2 v[238:239], v225, s[24:27], s51 offen
  buffer_load_dwordx2 v[246:247], v225, s[24:27], s51 offen offset:8
  buffer_load_dwordx2 v[240:241], v226, s[24:27], s51 offen
  buffer_load_dwordx2 v[248:249], v226, s[24:27], s51 offen offset:8
  buffer_load_dwordx2 v[242:243], v227, s[24:27], s51 offen
  buffer_load_dwordx2 v[250:251], v227, s[24:27], s51 offen offset:8
  s_waitcnt vmcnt(0)
  v_xor_b32 v236, v236, v12
  v_xor_b32 v237, v237, v12
  v_xor_b32 v238, v238, v12
  v_xor_b32 v239, v239, v12
  v_xor_b32 v240, v240, v12
  v_xor_b32 v241, v241, v12
  v_xor_b32 v242, v242, v12
  v_xor_b32 v243, v243, v12
  ds_read_u16 v224, v236 offset:0
  ds_read_u16 v225, v237 offset:0
  ds_read_u16 v226, v238 offset:0
  ds_read_u16 v227, v239 offset:0
  ds_read_u16 v228, v240 offset:0
  ds_read_u16 v229, v241 offset:0
  ds_read_u16 v230, v242 offset:0
  ds_read_u16 v231, v243 offset:0
  v_xor_b32 v245, v245, v0
  v_xor_b32 v247, v247, v0
  v_xor_b32 v249, v249, v0
  v_xor_b32 v251, v251, v0
  s_waitcnt lgkmcnt(0)
  v_lshl_or_b32 v232, v225, 16, v224
  v_lshl_or_b32 v233, v227, 16, v226
  v_lshl_or_b32 v234, v229, 16, v228
  v_lshl_or_b32 v235, v231, 16, v230
  v_pk_min_u16 v228, v245, s64
  v_pk_add_u16 v228, v228, s65
  v_and_b32 v228, v228, v244
  v_pk_min_u16 v229, v247, s64
  v_pk_add_u16 v229, v229, s65
  v_and_b32 v229, v229, v246
  v_pk_min_u16 v230, v249, s64
  v_pk_add_u16 v230, v230, s65
  v_and_b32 v230, v230, v248
  v_pk_min_u16 v231, v251, s64
  v_pk_add_u16 v231, v231, s65
  v_and_b32 v231, v231, v250
  s_nop 1
  v_mfma_f32_16x16x32_bf16 v[64:67], v[228:231], v[232:235], v[64:67]
  s_nop 7
  v_xor_b32 v228, 262148, v245
  v_pk_min_u16 v228, v228, s64
  v_pk_add_u16 v228, v228, s65
  v_and_b32 v228, v228, v244
  v_xor_b32 v229, 262148, v247
  v_pk_min_u16 v229, v229, s64
  v_pk_add_u16 v229, v229, s65
  v_and_b32 v229, v229, v246
  v_xor_b32 v230, 262148, v249
  v_pk_min_u16 v230, v230, s64
  v_pk_add_u16 v230, v230, s65
  v_and_b32 v230, v230, v248
  v_xor_b32 v231, 262148, v251
  v_pk_min_u16 v231, v231, s64
  v_pk_add_u16 v231, v231, s65
  v_and_b32 v231, v231, v250
  s_nop 1
  v_mfma_f32_16x16x32_bf16 v[68:71], v[228:231], v[232:235], v[68:71]
  s_nop 7
  v_xor_b32 v228, 2097184, v245
  v_pk_min_u16 v228, v228, s64
  v_pk_add_u16 v228, v228, s65
  v_and_b32 v228, v228, v244
  v_xor_b32 v229, 2097184, v247
  v_pk_min_u16 v229, v229, s64
  v_pk_add_u16 v229, v229, s65
  v_and_b32 v229, v229, v246
  v_xor_b32 v230, 2097184, v249
  v_pk_min_u16 v230, v230, s64
  v_pk_add_u16 v230, v230, s65
  v_and_b32 v230, v230, v248
  v_xor_b32 v231, 2097184, v251
  v_pk_min_u16 v231, v231, s64
  v_pk_add_u16 v231, v231, s65
  v_and_b32 v231, v231, v250
  s_nop 1
  v_mfma_f32_16x16x32_bf16 v[72:75], v[228:231], v[232:235], v[72:75]
  s_nop 7
  v_xor_b32 v228, 2359332, v245
  v_pk_min_u16 v228, v228, s64
  v_pk_add_u16 v228, v228, s65
  v_and_b32 v228, v228, v244
  v_xor_b32 v229, 2359332, v247
  v_pk_min_u16 v229, v229, s64
  v_pk_add_u16 v229, v229, s65
  v_and_b32 v229, v229, v246
  v_xor_b32 v230, 2359332, v249
  v_pk_min_u16 v230, v230, s64
  v_pk_add_u16 v230, v230, s65
  v_and_b32 v230, v230, v248
  v_xor_b32 v231, 2359332, v251
  v_pk_min_u16 v231, v231, s64
  v_pk_add_u16 v231, v231, s65
  v_and_b32 v231, v231, v250
  s_nop 1
  v_mfma_f32_16x16x32_bf16 v[76:79], v[228:231], v[232:235], v[76:79]
  s_nop 7
  s_add_u32 s57, s57, 1
  s_cmp_lt_u32 s57, s39
  s_cbranch_scc1 Lslowloop_f
  s_branch Lslowback_f
Lslow_b0:
  s_mov_b32 s57, 4
Lslowloop_b0:
  v_mbcnt_lo_u32_b32 v13, -1, 0
  v_mbcnt_hi_u32_b32 v13, -1, v13
  s_lshl_b32 s52, s57, 4
  v_add_u32 v13, s52, v13
  v_lshlrev_b32 v254, 4, v13
  s_mov_b32 s44, -1
  s_add_u32 s44, s44, s80
  s_lshl_b32 s45, s80, 4
  s_sub_u32 s45, 16384, s45
  v_sub_u32 v15, s44, v13
  v_ashrrev_i32 v15, 31, v15
  v_and_b32 v15, s45, v15
  v_add_u32 v254, v254, v15
  s_add_u32 s44, s44, s81
  s_lshl_b32 s45, s81, 4
  s_sub_u32 s45, 16384, s45
  v_sub_u32 v15, s44, v13
  v_ashrrev_i32 v15, 31, v15
  v_and_b32 v15, s45, v15
  v_add_u32 v254, v254, v15
  s_add_u32 s44, s44, s82
  s_lshl_b32 s45, s82, 4
  s_sub_u32 s45, 16384, s45
  v_sub_u32 v15, s44, v13
  v_ashrrev_i32 v15, 31, v15
  v_and_b32 v15, s45, v15
  v_add_u32 v254, v254, v15
  s_add_u32 s44, s44, s83
  s_lshl_b32 s45, s83, 4
  s_sub_u32 s45, 16384, s45
  v_sub_u32 v15, s44, v13
  v_ashrrev_i32 v15, 31, v15
  v_and_b32 v15, s45, v15
  v_add_u32 v254, v254, v15
  s_add_u32 s44, s44, s84
  s_lshl_b32 s45, s84, 4
  s_sub_u32 s45, 16384, s45
  v_sub_u32 v15, s44, v13
  v_ashrrev_i32 v15, 31, v15
  v_and_b32 v15, s45, v15
  v_add_u32 v254, v254, v15
  s_add_u32 s44, s44, s85
  s_lshl_b32 s45, s85, 4
  s_sub_u32 s45, 16384, s45
  v_sub_u32 v15, s44, v13
  v_ashrrev_i32 v15, 31, v15
  v_and_b32 v15, s45, v15
  v_add_u32 v254, v254, v15
  s_add_u32 s44, s44, s86
  s_lshl_b32 s45, s86, 4
  s_sub_u32 s45, 16384, s45
  v_sub_u32 v15, s44, v13
  v_ashrrev_i32 v15, 31, v15
  v_and_b32 v15, s45, v15
  v_add_u32 v254, v254, v15
  s_add_u32 s44, s44, s87
  s_lshl_b32 s45, s87, 4
  s_sub_u32 s45, 16384, s45
  v_sub_u32 v15, s44, v13
  v_ashrrev_i32 v15, 31, v15
  v_and_b32 v15, s45, v15
  v_add_u32 v254, v254, v15
  s_add_u32 s44, s44, s88
  s_lshl_b32 s45, s88, 4
  s_sub_u32 s45, 16384, s45
  v_sub_u32 v15, s44, v13
  v_ashrrev_i32 v15, 31, v15
  v_and_b32 v15, s45, v15
  v_add_u32 v254, v254, v15
  s_add_u32 s44, s44, s89
  s_lshl_b32 s45, s89, 4
  s_sub_u32 s45, 16384, s45
  v_sub_u32 v15, s44, v13
  v_ashrrev_i32 v15, 31, v15
  v_and_b32 v15, s45, v15
  v_add_u32 v254, v254, v15
  s_add_u32 s44, s44, s90
  s_lshl_b32 s45, s90, 4
  s_sub_u32 s45, 16384, s45
  v_sub_u32 v15, s44, v13
  v_ashrrev_i32 v15, 31, v15
  v_and_b32 v15, s45, v15
  v_add_u32 v254, v254, v15
  s_add_u32 s44, s44, s91
  s_lshl_b32 s45, s91, 4
  s_sub_u32 s45, 16384, s45
  v_sub_u32 v15, s44, v13
  v_ashrrev_i32 v15, 31, v15
  v_and_b32 v15, s45, v15
  v_add_u32 v254, v254, v15
  s_add_u32 s44, s44, s92
  s_lshl_b32 s45, s92, 4
  s_sub_u32 s45, 16384, s45
  v_sub_u32 v15, s44, v13
  v_ashrrev_i32 v15, 31, v15
  v_and_b32 v15, s45, v15
  v_add_u32 v254, v254, v15
  s_add_u32 s44, s44, s93
  s_lshl_b32 s45, s93, 4
  s_sub_u32 s45, 16384, s45
  v_sub_u32 v15, s44, v13
  v_ashrrev_i32 v15, 31, v15
  v_and_b32 v15, s45, v15
  v_add_u32 v254, v254, v15
  s_add_u32 s44, s44, s94
  s_lshl_b32 s45, s94, 4
  s_sub_u32 s45, 16384, s45
  v_sub_u32 v15, s44, v13
  v_ashrrev_i32 v15, 31, v15
  v_and_b32 v15, s45, v15
  v_add_u32 v254, v254, v15
  s_add_u32 s44, s44, s95
  v_sub_u32 v15, s44, v13
  v_ashrrev_i32 v15, 31, v15
  v_and_b32 v15, 1073741824, v15
  v_or_b32 v254, v254, v15
  ds_bpermute_b32 v224, v252, v254 offset:0
  ds_bpermute_b32 v225, v252, v254 offset:4
  ds_bpermute_b32 v226, v252, v254 offset:8
  ds_bpermute_b32 v227, v252, v254 offset:12
  s_waitcnt lgkmcnt(0)
  buffer_load_dwordx2 v[236:237], v224, s[24:27], s51 offen
  buffer_load_dwordx2 v[244:245], v224, s[24:27], s51 offen offset:8
  buffer_load_dwordx2 v[238:239], v225, s[24:27], s51 offen
  buffer_load_dwordx2 v[246:247], v225, s[24:27], s51 offen offset:8
  buffer_load_dwordx2 v[240:241], v226, s[24:27], s51 offen
  buffer_load_dwordx2 v[248:249], v226, s[24:27], s51 offen offset:8
  buffer_load_dwordx2 v[242:243], v227, s[24:27], s51 offen
  buffer_load_dwordx2 v[250:251], v227, s[24:27], s51 offen offset:8
  s_waitcnt vmcnt(0)
  v_xor_b32 v236, v236, v12
  v_xor_b32 v237, v237, v12
  v_xor_b32 v238, v238, v12
  v_xor_b32 v239, v239, v12
  v_xor_b32 v240, v240, v12
  v_xor_b32 v241, v241, v12
  v_xor_b32 v242, v242, v12
  v_xor_b32 v243, v243, v12
  ds_read_u16 v224, v236 offset:2048
  ds_read_u16 v225, v237 offset:2048
  ds_read_u16 v226, v238 offset:2048
  ds_read_u16 v227, v239 offset:2048
  ds_read_u16 v228, v240 offset:2048
  ds_read_u16 v229, v241 offset:2048
  ds_read_u16 v230, v242 offset:2048
  ds_read_u16 v231, v243 offset:2048
  v_xor_b32 v245, v245, v0
  v_xor_b32 v247, v247, v0
  v_xor_b32 v249, v249, v0
  v_xor_b32 v251, v251, v0
  s_waitcnt lgkmcnt(0)
  v_lshl_or_b32 v232, v225, 16, v224
  v_lshl_or_b32 v233, v227, 16, v226
  v_lshl_or_b32 v234, v229, 16, v228
  v_lshl_or_b32 v235, v231, 16, v230
  v_pk_min_u16 v228, v245, s64
  v_pk_add_u16 v228, v228, s65
  v_and_b32 v228, v228, v244
  v_pk_min_u16 v229, v247, s64
  v_pk_add_u16 v229, v229, s65
  v_and_b32 v229, v229, v246
  v_pk_min_u16 v230, v249, s64
  v_pk_add_u16 v230, v230, s65
  v_and_b32 v230, v230, v248
  v_pk_min_u16 v231, v251, s64
  v_pk_add_u16 v231, v231, s65
  v_and_b32 v231, v231, v250
  s_nop 1
  v_mfma_f32_16x16x32_bf16 v[80:83], v[228:231], v[232:235], v[80:83]
  s_nop 7
  v_xor_b32 v228, 262148, v245
  v_pk_min_u16 v228, v228, s64
  v_pk_add_u16 v228, v228, s65
  v_and_b32 v228, v228, v244
  v_xor_b32 v229, 262148, v247
  v_pk_min_u16 v229, v229, s64
  v_pk_add_u16 v229, v229, s65
  v_and_b32 v229, v229, v246
  v_xor_b32 v230, 262148, v249
  v_pk_min_u16 v230, v230, s64
  v_pk_add_u16 v230, v230, s65
  v_and_b32 v230, v230, v248
  v_xor_b32 v231, 262148, v251
  v_pk_min_u16 v231, v231, s64
  v_pk_add_u16 v231, v231, s65
  v_and_b32 v231, v231, v250
  s_nop 1
  v_mfma_f32_16x16x32_bf16 v[84:87], v[228:231], v[232:235], v[84:87]
  s_nop 7
  v_xor_b32 v228, 2097184, v245
  v_pk_min_u16 v228, v228, s64
  v_pk_add_u16 v228, v228, s65
  v_and_b32 v228, v228, v244
  v_xor_b32 v229, 2097184, v247
  v_pk_min_u16 v229, v229, s64
  v_pk_add_u16 v229, v229, s65
  v_and_b32 v229, v229, v246
  v_xor_b32 v230, 2097184, v249
  v_pk_min_u16 v230, v230, s64
  v_pk_add_u16 v230, v230, s65
  v_and_b32 v230, v230, v248
  v_xor_b32 v231, 2097184, v251
  v_pk_min_u16 v231, v231, s64
  v_pk_add_u16 v231, v231, s65
  v_and_b32 v231, v231, v250
  s_nop 1
  v_mfma_f32_16x16x32_bf16 v[88:91], v[228:231], v[232:235], v[88:91]
  s_nop 7
  v_xor_b32 v228, 2359332, v245
  v_pk_min_u16 v228, v228, s64
  v_pk_add_u16 v228, v228, s65
  v_and_b32 v228, v228, v244
  v_xor_b32 v229, 2359332, v247
  v_pk_min_u16 v229, v229, s64
  v_pk_add_u16 v229, v229, s65
  v_and_b32 v229, v229, v246
  v_xor_b32 v230, 2359332, v249
  v_pk_min_u16 v230, v230, s64
  v_pk_add_u16 v230, v230, s65
  v_and_b32 v230, v230, v248
  v_xor_b32 v231, 2359332, v251
  v_pk_min_u16 v231, v231, s64
  v_pk_add_u16 v231, v231, s65
  v_and_b32 v231, v231, v250
  s_nop 1
  v_mfma_f32_16x16x32_bf16 v[92:95], v[228:231], v[232:235], v[92:95]
  s_nop 7
  s_add_u32 s57, s57, 1
  s_cmp_lt_u32 s57, s39
  s_cbranch_scc1 Lslowloop_b0
  s_branch Lslowback_b0
Lslow_b1:
  s_mov_b32 s57, 4
Lslowloop_b1:
  v_mbcnt_lo_u32_b32 v13, -1, 0
  v_mbcnt_hi_u32_b32 v13, -1, v13
  s_lshl_b32 s52, s57, 4
  v_add_u32 v13, s52, v13
  v_lshlrev_b32 v254, 4, v13
  s_mov_b32 s44, -1
  s_add_u32 s44, s44, s80
  s_lshl_b32 s45, s80, 4
  s_sub_u32 s45, 16384, s45
  v_sub_u32 v15, s44, v13
  v_ashrrev_i32 v15, 31, v15
  v_and_b32 v15, s45, v15
  v_add_u32 v254, v254, v15
  s_add_u32 s44, s44, s81
  s_lshl_b32 s45, s81, 4
  s_sub_u32 s45, 16384, s45
  v_sub_u32 v15, s44, v13
  v_ashrrev_i32 v15, 31, v15
  v_and_b32 v15, s45, v15
  v_add_u32 v254, v254, v15
  s_add_u32 s44, s44, s82
  s_lshl_b32 s45, s82, 4
  s_sub_u32 s45, 16384, s45
  v_sub_u32 v15, s44, v13
  v_ashrrev_i32 v15, 31, v15
  v_and_b32 v15, s45, v15
  v_add_u32 v254, v254, v15
  s_add_u32 s44, s44, s83
  s_lshl_b32 s45, s83, 4
  s_sub_u32 s45, 16384, s45
  v_sub_u32 v15, s44, v13
  v_ashrrev_i32 v15, 31, v15
  v_and_b32 v15, s45, v15
  v_add_u32 v254, v254, v15
  s_add_u32 s44, s44, s84
  s_lshl_b32 s45, s84, 4
  s_sub_u32 s45, 16384, s45
  v_sub_u32 v15, s44, v13
  v_ashrrev_i32 v15, 31, v15
  v_and_b32 v15, s45, v15
  v_add_u32 v254, v254, v15
  s_add_u32 s44, s44, s85
  s_lshl_b32 s45, s85, 4
  s_sub_u32 s45, 16384, s45
  v_sub_u32 v15, s44, v13
  v_ashrrev_i32 v15, 31, v15
  v_and_b32 v15, s45, v15
  v_add_u32 v254, v254, v15
  s_add_u32 s44, s44, s86
  s_lshl_b32 s45, s86, 4
  s_sub_u32 s45, 16384, s45
  v_sub_u32 v15, s44, v13
  v_ashrrev_i32 v15, 31, v15
  v_and_b32 v15, s45, v15
  v_add_u32 v254, v254, v15
  s_add_u32 s44, s44, s87
  s_lshl_b32 s45, s87, 4
  s_sub_u32 s45, 16384, s45
  v_sub_u32 v15, s44, v13
  v_ashrrev_i32 v15, 31, v15
  v_and_b32 v15, s45, v15
  v_add_u32 v254, v254, v15
  s_add_u32 s44, s44, s88
  s_lshl_b32 s45, s88, 4
  s_sub_u32 s45, 16384, s45
  v_sub_u32 v15, s44, v13
  v_ashrrev_i32 v15, 31, v15
  v_and_b32 v15, s45, v15
  v_add_u32 v254, v254, v15
  s_add_u32 s44, s44, s89
  s_lshl_b32 s45, s89, 4
  s_sub_u32 s45, 16384, s45
  v_sub_u32 v15, s44, v13
  v_ashrrev_i32 v15, 31, v15
  v_and_b32 v15, s45, v15
  v_add_u32 v254, v254, v15
  s_add_u32 s44, s44, s90
  s_lshl_b32 s45, s90, 4
  s_sub_u32 s45, 16384, s45
  v_sub_u32 v15, s44, v13
  v_ashrrev_i32 v15, 31, v15
  v_and_b32 v15, s45, v15
  v_add_u32 v254, v254, v15
  s_add_u32 s44, s44, s91
  s_lshl_b32 s45, s91, 4
  s_sub_u32 s45, 16384, s45
  v_sub_u32 v15, s44, v13
  v_ashrrev_i32 v15, 31, v15
  v_and_b32 v15, s45, v15
  v_add_u32 v254, v254, v15
  s_add_u32 s44, s44, s92
  s_lshl_b32 s45, s92, 4
  s_sub_u32 s45, 16384, s45
  v_sub_u32 v15, s44, v13
  v_ashrrev_i32 v15, 31, v15
  v_and_b32 v15, s45, v15
  v_add_u32 v254, v254, v15
  s_add_u32 s44, s44, s93
  s_lshl_b32 s45, s93, 4
  s_sub_u32 s45, 16384, s45
  v_sub_u32 v15, s44, v13
  v_ashrrev_i32 v15, 31, v15
  v_and_b32 v15, s45, v15
  v_add_u32 v254, v254, v15
  s_add_u32 s44, s44, s94
  s_lshl_b32 s45, s94, 4
  s_sub_u32 s45, 16384, s45
  v_sub_u32 v15, s44, v13
  v_ashrrev_i32 v15, 31, v15
  v_and_b32 v15, s45, v15
  v_add_u32 v254, v254, v15
  s_add_u32 s44, s44, s95
  v_sub_u32 v15, s44, v13
  v_ashrrev_i32 v15, 31, v15
  v_and_b32 v15, 1073741824, v15
  v_or_b32 v254, v254, v15
  ds_bpermute_b32 v224, v252, v254 offset:0
  ds_bpermute_b32 v225, v252, v254 offset:4
  ds_bpermute_b32 v226, v252, v254 offset:8
  ds_bpermute_b32 v227, v252, v254 offset:12
  s_waitcnt lgkmcnt(0)
  buffer_load_dwordx2 v[236:237], v224, s[24:27], s51 offen
  buffer_load_dwordx2 v[244:245], v224, s[24:27], s51 offen offset:8
  buffer_load_dwordx2 v[238:239], v225, s[24:27], s51 offen
  buffer_load_dwordx2 v[246:247], v225, s[24:27], s51 offen offset:8
  buffer_load_dwordx2 v[240:241], v226, s[24:27], s51 offen
  buffer_load_dwordx2 v[248:249], v226, s[24:27], s51 offen offset:8
  buffer_load_dwordx2 v[242:243], v227, s[24:27], s51 offen
  buffer_load_dwordx2 v[250:251], v227, s[24:27], s51 offen offset:8
  s_waitcnt vmcnt(0)
  v_xor_b32 v236, v236, v12
  v_xor_b32 v237, v237, v12
  v_xor_b32 v238, v238, v12
  v_xor_b32 v239, v239, v12
  v_xor_b32 v240, v240, v12
  v_xor_b32 v241, v241, v12
  v_xor_b32 v242, v242, v12
  v_xor_b32 v243, v243, v12
  ds_read_u16 v224, v236 offset:4096
  ds_read_u16 v225, v237 offset:4096
  ds_read_u16 v226, v238 offset:4096
  ds_read_u16 v227, v239 offset:4096
  ds_read_u16 v228, v240 offset:4096
  ds_read_u16 v229, v241 offset:4096
  ds_read_u16 v230, v242 offset:4096
  ds_read_u16 v231, v243 offset:4096
  v_xor_b32 v245, v245, v0
  v_xor_b32 v247, v247, v0
  v_xor_b32 v249, v249, v0
  v_xor_b32 v251, v251, v0
  s_waitcnt lgkmcnt(0)
  v_lshl_or_b32 v232, v225, 16, v224
  v_lshl_or_b32 v233, v227, 16, v226
  v_lshl_or_b32 v234, v229, 16, v228
  v_lshl_or_b32 v235, v231, 16, v230
  v_pk_min_u16 v228, v245, s64
  v_pk_add_u16 v228, v228, s65
  v_and_b32 v228, v228, v244
  v_pk_min_u16 v229, v247, s64
  v_pk_add_u16 v229, v229, s65
  v_and_b32 v229, v229, v246
  v_pk_min_u16 v230, v249, s64
  v_pk_add_u16 v230, v230, s65
  v_and_b32 v230, v230, v248
  v_pk_min_u16 v231, v251, s64
  v_pk_add_u16 v231, v231, s65
  v_and_b32 v231, v231, v250
  s_nop 1
  v_mfma_f32_16x16x32_bf16 v[64:67], v[228:231], v[232:235], v[64:67]
  s_nop 7
  v_xor_b32 v228, 262148, v245
  v_pk_min_u16 v228, v228, s64
  v_pk_add_u16 v228, v228, s65
  v_and_b32 v228, v228, v244
  v_xor_b32 v229, 262148, v247
  v_pk_min_u16 v229, v229, s64
  v_pk_add_u16 v229, v229, s65
  v_and_b32 v229, v229, v246
  v_xor_b32 v230, 262148, v249
  v_pk_min_u16 v230, v230, s64
  v_pk_add_u16 v230, v230, s65
  v_and_b32 v230, v230, v248
  v_xor_b32 v231, 262148, v251
  v_pk_min_u16 v231, v231, s64
  v_pk_add_u16 v231, v231, s65
  v_and_b32 v231, v231, v250
  s_nop 1
  v_mfma_f32_16x16x32_bf16 v[68:71], v[228:231], v[232:235], v[68:71]
  s_nop 7
  v_xor_b32 v228, 2097184, v245
  v_pk_min_u16 v228, v228, s64
  v_pk_add_u16 v228, v228, s65
  v_and_b32 v228, v228, v244
  v_xor_b32 v229, 2097184, v247
  v_pk_min_u16 v229, v229, s64
  v_pk_add_u16 v229, v229, s65
  v_and_b32 v229, v229, v246
  v_xor_b32 v230, 2097184, v249
  v_pk_min_u16 v230, v230, s64
  v_pk_add_u16 v230, v230, s65
  v_and_b32 v230, v230, v248
  v_xor_b32 v231, 2097184, v251
  v_pk_min_u16 v231, v231, s64
  v_pk_add_u16 v231, v231, s65
  v_and_b32 v231, v231, v250
  s_nop 1
  v_mfma_f32_16x16x32_bf16 v[72:75], v[228:231], v[232:235], v[72:75]
  s_nop 7
  v_xor_b32 v228, 2359332, v245
  v_pk_min_u16 v228, v228, s64
  v_pk_add_u16 v228, v228, s65
  v_and_b32 v228, v228, v244
  v_xor_b32 v229, 2359332, v247
  v_pk_min_u16 v229, v229, s64
  v_pk_add_u16 v229, v229, s65
  v_and_b32 v229, v229, v246
  v_xor_b32 v230, 2359332, v249
  v_pk_min_u16 v230, v230, s64
  v_pk_add_u16 v230, v230, s65
  v_and_b32 v230, v230, v248
  v_xor_b32 v231, 2359332, v251
  v_pk_min_u16 v231, v231, s64
  v_pk_add_u16 v231, v231, s65
  v_and_b32 v231, v231, v250
  s_nop 1
  v_mfma_f32_16x16x32_bf16 v[76:79], v[228:231], v[232:235], v[76:79]
  s_nop 7
  s_add_u32 s57, s57, 1
  s_cmp_lt_u32 s57, s39
  s_cbranch_scc1 Lslowloop_b1
  s_branch Lslowback_b1
Lslow_b2:
  s_mov_b32 s57, 4
Lslowloop_b2:
  v_mbcnt_lo_u32_b32 v13, -1, 0
  v_mbcnt_hi_u32_b32 v13, -1, v13
  s_lshl_b32 s52, s57, 4
  v_add_u32 v13, s52, v13
  v_lshlrev_b32 v254, 4, v13
  s_mov_b32 s44, -1
  s_add_u32 s44, s44, s80
  s_lshl_b32 s45, s80, 4
  s_sub_u32 s45, 16384, s45
  v_sub_u32 v15, s44, v13
  v_ashrrev_i32 v15, 31, v15
  v_and_b32 v15, s45, v15
  v_add_u32 v254, v254, v15
  s_add_u32 s44, s44, s81
  s_lshl_b32 s45, s81, 4
  s_sub_u32 s45, 16384, s45
  v_sub_u32 v15, s44, v13
  v_ashrrev_i32 v15, 31, v15
  v_and_b32 v15, s45, v15
  v_add_u32 v254, v254, v15
  s_add_u32 s44, s44, s82
  s_lshl_b32 s45, s82, 4
  s_sub_u32 s45, 16384, s45
  v_sub_u32 v15, s44, v13
  v_ashrrev_i32 v15, 31, v15
  v_and_b32 v15, s45, v15
  v_add_u32 v254, v254, v15
  s_add_u32 s44, s44, s83
  s_lshl_b32 s45, s83, 4
  s_sub_u32 s45, 16384, s45
  v_sub_u32 v15, s44, v13
  v_ashrrev_i32 v15, 31, v15
  v_and_b32 v15, s45, v15
  v_add_u32 v254, v254, v15
  s_add_u32 s44, s44, s84
  s_lshl_b32 s45, s84, 4
  s_sub_u32 s45, 16384, s45
  v_sub_u32 v15, s44, v13
  v_ashrrev_i32 v15, 31, v15
  v_and_b32 v15, s45, v15
  v_add_u32 v254, v254, v15
  s_add_u32 s44, s44, s85
  s_lshl_b32 s45, s85, 4
  s_sub_u32 s45, 16384, s45
  v_sub_u32 v15, s44, v13
  v_ashrrev_i32 v15, 31, v15
  v_and_b32 v15, s45, v15
  v_add_u32 v254, v254, v15
  s_add_u32 s44, s44, s86
  s_lshl_b32 s45, s86, 4
  s_sub_u32 s45, 16384, s45
  v_sub_u32 v15, s44, v13
  v_ashrrev_i32 v15, 31, v15
  v_and_b32 v15, s45, v15
  v_add_u32 v254, v254, v15
  s_add_u32 s44, s44, s87
  s_lshl_b32 s45, s87, 4
  s_sub_u32 s45, 16384, s45
  v_sub_u32 v15, s44, v13
  v_ashrrev_i32 v15, 31, v15
  v_and_b32 v15, s45, v15
  v_add_u32 v254, v254, v15
  s_add_u32 s44, s44, s88
  s_lshl_b32 s45, s88, 4
  s_sub_u32 s45, 16384, s45
  v_sub_u32 v15, s44, v13
  v_ashrrev_i32 v15, 31, v15
  v_and_b32 v15, s45, v15
  v_add_u32 v254, v254, v15
  s_add_u32 s44, s44, s89
  s_lshl_b32 s45, s89, 4
  s_sub_u32 s45, 16384, s45
  v_sub_u32 v15, s44, v13
  v_ashrrev_i32 v15, 31, v15
  v_and_b32 v15, s45, v15
  v_add_u32 v254, v254, v15
  s_add_u32 s44, s44, s90
  s_lshl_b32 s45, s90, 4
  s_sub_u32 s45, 16384, s45
  v_sub_u32 v15, s44, v13
  v_ashrrev_i32 v15, 31, v15
  v_and_b32 v15, s45, v15
  v_add_u32 v254, v254, v15
  s_add_u32 s44, s44, s91
  s_lshl_b32 s45, s91, 4
  s_sub_u32 s45, 16384, s45
  v_sub_u32 v15, s44, v13
  v_ashrrev_i32 v15, 31, v15
  v_and_b32 v15, s45, v15
  v_add_u32 v254, v254, v15
  s_add_u32 s44, s44, s92
  s_lshl_b32 s45, s92, 4
  s_sub_u32 s45, 16384, s45
  v_sub_u32 v15, s44, v13
  v_ashrrev_i32 v15, 31, v15
  v_and_b32 v15, s45, v15
  v_add_u32 v254, v254, v15
  s_add_u32 s44, s44, s93
  s_lshl_b32 s45, s93, 4
  s_sub_u32 s45, 16384, s45
  v_sub_u32 v15, s44, v13
  v_ashrrev_i32 v15, 31, v15
  v_and_b32 v15, s45, v15
  v_add_u32 v254, v254, v15
  s_add_u32 s44, s44, s94
  s_lshl_b32 s45, s94, 4
  s_sub_u32 s45, 16384, s45
  v_sub_u32 v15, s44, v13
  v_ashrrev_i32 v15, 31, v15
  v_and_b32 v15, s45, v15
  v_add_u32 v254, v254, v15
  s_add_u32 s44, s44, s95
  v_sub_u32 v15, s44, v13
  v_ashrrev_i32 v15, 31, v15
  v_and_b32 v15, 1073741824, v15
  v_or_b32 v254, v254, v15
  ds_bpermute_b32 v224, v252, v254 offset:0
  ds_bpermute_b32 v225, v252, v254 offset:4
  ds_bpermute_b32 v226, v252, v254 offset:8
  ds_bpermute_b32 v227, v252, v254 offset:12
  s_waitcnt lgkmcnt(0)
  buffer_load_dwordx2 v[236:237], v224, s[24:27], s51 offen
  buffer_load_dwordx2 v[244:245], v224, s[24:27], s51 offen offset:8
  buffer_load_dwordx2 v[238:239], v225, s[24:27], s51 offen
  buffer_load_dwordx2 v[246:247], v225, s[24:27], s51 offen offset:8
  buffer_load_dwordx2 v[240:241], v226, s[24:27], s51 offen
  buffer_load_dwordx2 v[248:249], v226, s[24:27], s51 offen offset:8
  buffer_load_dwordx2 v[242:243], v227, s[24:27], s51 offen
  buffer_load_dwordx2 v[250:251], v227, s[24:27], s51 offen offset:8
  s_waitcnt vmcnt(0)
  v_xor_b32 v236, v236, v12
  v_xor_b32 v237, v237, v12
  v_xor_b32 v238, v238, v12
  v_xor_b32 v239, v239, v12
  v_xor_b32 v240, v240, v12
  v_xor_b32 v241, v241, v12
  v_xor_b32 v242, v242, v12
  v_xor_b32 v243, v243, v12
  ds_read_u16 v224, v236 offset:6144
  ds_read_u16 v225, v237 offset:6144
  ds_read_u16 v226, v238 offset:6144
  ds_read_u16 v227, v239 offset:6144
  ds_read_u16 v228, v240 offset:6144
  ds_read_u16 v229, v241 offset:6144
  ds_read_u16 v230, v242 offset:6144
  ds_read_u16 v231, v243 offset:6144
  v_xor_b32 v245, v245, v0
  v_xor_b32 v247, v247, v0
  v_xor_b32 v249, v249, v0
  v_xor_b32 v251, v251, v0
  s_waitcnt lgkmcnt(0)
  v_lshl_or_b32 v232, v225, 16, v224
  v_lshl_or_b32 v233, v227, 16, v226
  v_lshl_or_b32 v234, v229, 16, v228
  v_lshl_or_b32 v235, v231, 16, v230
  v_pk_min_u16 v228, v245, s64
  v_pk_add_u16 v228, v228, s65
  v_and_b32 v228, v228, v244
  v_pk_min_u16 v229, v247, s64
  v_pk_add_u16 v229, v229, s65
  v_and_b32 v229, v229, v246
  v_pk_min_u16 v230, v249, s64
  v_pk_add_u16 v230, v230, s65
  v_and_b32 v230, v230, v248
  v_pk_min_u16 v231, v251, s64
  v_pk_add_u16 v231, v231, s65
  v_and_b32 v231, v231, v250
  s_nop 1
  v_mfma_f32_16x16x32_bf16 v[80:83], v[228:231], v[232:235], v[80:83]
  s_nop 7
  v_xor_b32 v228, 262148, v245
  v_pk_min_u16 v228, v228, s64
  v_pk_add_u16 v228, v228, s65
  v_and_b32 v228, v228, v244
  v_xor_b32 v229, 262148, v247
  v_pk_min_u16 v229, v229, s64
  v_pk_add_u16 v229, v229, s65
  v_and_b32 v229, v229, v246
  v_xor_b32 v230, 262148, v249
  v_pk_min_u16 v230, v230, s64
  v_pk_add_u16 v230, v230, s65
  v_and_b32 v230, v230, v248
  v_xor_b32 v231, 262148, v251
  v_pk_min_u16 v231, v231, s64
  v_pk_add_u16 v231, v231, s65
  v_and_b32 v231, v231, v250
  s_nop 1
  v_mfma_f32_16x16x32_bf16 v[84:87], v[228:231], v[232:235], v[84:87]
  s_nop 7
  v_xor_b32 v228, 2097184, v245
  v_pk_min_u16 v228, v228, s64
  v_pk_add_u16 v228, v228, s65
  v_and_b32 v228, v228, v244
  v_xor_b32 v229, 2097184, v247
  v_pk_min_u16 v229, v229, s64
  v_pk_add_u16 v229, v229, s65
  v_and_b32 v229, v229, v246
  v_xor_b32 v230, 2097184, v249
  v_pk_min_u16 v230, v230, s64
  v_pk_add_u16 v230, v230, s65
  v_and_b32 v230, v230, v248
  v_xor_b32 v231, 2097184, v251
  v_pk_min_u16 v231, v231, s64
  v_pk_add_u16 v231, v231, s65
  v_and_b32 v231, v231, v250
  s_nop 1
  v_mfma_f32_16x16x32_bf16 v[88:91], v[228:231], v[232:235], v[88:91]
  s_nop 7
  v_xor_b32 v228, 2359332, v245
  v_pk_min_u16 v228, v228, s64
  v_pk_add_u16 v228, v228, s65
  v_and_b32 v228, v228, v244
  v_xor_b32 v229, 2359332, v247
  v_pk_min_u16 v229, v229, s64
  v_pk_add_u16 v229, v229, s65
  v_and_b32 v229, v229, v246
  v_xor_b32 v230, 2359332, v249
  v_pk_min_u16 v230, v230, s64
  v_pk_add_u16 v230, v230, s65
  v_and_b32 v230, v230, v248
  v_xor_b32 v231, 2359332, v251
  v_pk_min_u16 v231, v231, s64
  v_pk_add_u16 v231, v231, s65
  v_and_b32 v231, v231, v250
  s_nop 1
  v_mfma_f32_16x16x32_bf16 v[92:95], v[228:231], v[232:235], v[92:95]
  s_nop 7
  s_add_u32 s57, s57, 1
  s_cmp_lt_u32 s57, s39
  s_cbranch_scc1 Lslowloop_b2
  s_branch Lslowback_b2
Lslow_b3:
  s_mov_b32 s57, 4
Lslowloop_b3:
  v_mbcnt_lo_u32_b32 v13, -1, 0
  v_mbcnt_hi_u32_b32 v13, -1, v13
  s_lshl_b32 s52, s57, 4
  v_add_u32 v13, s52, v13
  v_lshlrev_b32 v254, 4, v13
  s_mov_b32 s44, -1
  s_add_u32 s44, s44, s80
  s_lshl_b32 s45, s80, 4
  s_sub_u32 s45, 16384, s45
  v_sub_u32 v15, s44, v13
  v_ashrrev_i32 v15, 31, v15
  v_and_b32 v15, s45, v15
  v_add_u32 v254, v254, v15
  s_add_u32 s44, s44, s81
  s_lshl_b32 s45, s81, 4
  s_sub_u32 s45, 16384, s45
  v_sub_u32 v15, s44, v13
  v_ashrrev_i32 v15, 31, v15
  v_and_b32 v15, s45, v15
  v_add_u32 v254, v254, v15
  s_add_u32 s44, s44, s82
  s_lshl_b32 s45, s82, 4
  s_sub_u32 s45, 16384, s45
  v_sub_u32 v15, s44, v13
  v_ashrrev_i32 v15, 31, v15
  v_and_b32 v15, s45, v15
  v_add_u32 v254, v254, v15
  s_add_u32 s44, s44, s83
  s_lshl_b32 s45, s83, 4
  s_sub_u32 s45, 16384, s45
  v_sub_u32 v15, s44, v13
  v_ashrrev_i32 v15, 31, v15
  v_and_b32 v15, s45, v15
  v_add_u32 v254, v254, v15
  s_add_u32 s44, s44, s84
  s_lshl_b32 s45, s84, 4
  s_sub_u32 s45, 16384, s45
  v_sub_u32 v15, s44, v13
  v_ashrrev_i32 v15, 31, v15
  v_and_b32 v15, s45, v15
  v_add_u32 v254, v254, v15
  s_add_u32 s44, s44, s85
  s_lshl_b32 s45, s85, 4
  s_sub_u32 s45, 16384, s45
  v_sub_u32 v15, s44, v13
  v_ashrrev_i32 v15, 31, v15
  v_and_b32 v15, s45, v15
  v_add_u32 v254, v254, v15
  s_add_u32 s44, s44, s86
  s_lshl_b32 s45, s86, 4
  s_sub_u32 s45, 16384, s45
  v_sub_u32 v15, s44, v13
  v_ashrrev_i32 v15, 31, v15
  v_and_b32 v15, s45, v15
  v_add_u32 v254, v254, v15
  s_add_u32 s44, s44, s87
  s_lshl_b32 s45, s87, 4
  s_sub_u32 s45, 16384, s45
  v_sub_u32 v15, s44, v13
  v_ashrrev_i32 v15, 31, v15
  v_and_b32 v15, s45, v15
  v_add_u32 v254, v254, v15
  s_add_u32 s44, s44, s88
  s_lshl_b32 s45, s88, 4
  s_sub_u32 s45, 16384, s45
  v_sub_u32 v15, s44, v13
  v_ashrrev_i32 v15, 31, v15
  v_and_b32 v15, s45, v15
  v_add_u32 v254, v254, v15
  s_add_u32 s44, s44, s89
  s_lshl_b32 s45, s89, 4
  s_sub_u32 s45, 16384, s45
  v_sub_u32 v15, s44, v13
  v_ashrrev_i32 v15, 31, v15
  v_and_b32 v15, s45, v15
  v_add_u32 v254, v254, v15
  s_add_u32 s44, s44, s90
  s_lshl_b32 s45, s90, 4
  s_sub_u32 s45, 16384, s45
  v_sub_u32 v15, s44, v13
  v_ashrrev_i32 v15, 31, v15
  v_and_b32 v15, s45, v15
  v_add_u32 v254, v254, v15
  s_add_u32 s44, s44, s91
  s_lshl_b32 s45, s91, 4
  s_sub_u32 s45, 16384, s45
  v_sub_u32 v15, s44, v13
  v_ashrrev_i32 v15, 31, v15
  v_and_b32 v15, s45, v15
  v_add_u32 v254, v254, v15
  s_add_u32 s44, s44, s92
  s_lshl_b32 s45, s92, 4
  s_sub_u32 s45, 16384, s45
  v_sub_u32 v15, s44, v13
  v_ashrrev_i32 v15, 31, v15
  v_and_b32 v15, s45, v15
  v_add_u32 v254, v254, v15
  s_add_u32 s44, s44, s93
  s_lshl_b32 s45, s93, 4
  s_sub_u32 s45, 16384, s45
  v_sub_u32 v15, s44, v13
  v_ashrrev_i32 v15, 31, v15
  v_and_b32 v15, s45, v15
  v_add_u32 v254, v254, v15
  s_add_u32 s44, s44, s94
  s_lshl_b32 s45, s94, 4
  s_sub_u32 s45, 16384, s45
  v_sub_u32 v15, s44, v13
  v_ashrrev_i32 v15, 31, v15
  v_and_b32 v15, s45, v15
  v_add_u32 v254, v254, v15
  s_add_u32 s44, s44, s95
  v_sub_u32 v15, s44, v13
  v_ashrrev_i32 v15, 31, v15
  v_and_b32 v15, 1073741824, v15
  v_or_b32 v254, v254, v15
  ds_bpermute_b32 v224, v252, v254 offset:0
  ds_bpermute_b32 v225, v252, v254 offset:4
  ds_bpermute_b32 v226, v252, v254 offset:8
  ds_bpermute_b32 v227, v252, v254 offset:12
  s_waitcnt lgkmcnt(0)
  buffer_load_dwordx2 v[236:237], v224, s[24:27], s51 offen
  buffer_load_dwordx2 v[244:245], v224, s[24:27], s51 offen offset:8
  buffer_load_dwordx2 v[238:239], v225, s[24:27], s51 offen
  buffer_load_dwordx2 v[246:247], v225, s[24:27], s51 offen offset:8
  buffer_load_dwordx2 v[240:241], v226, s[24:27], s51 offen
  buffer_load_dwordx2 v[248:249], v226, s[24:27], s51 offen offset:8
  buffer_load_dwordx2 v[242:243], v227, s[24:27], s51 offen
  buffer_load_dwordx2 v[250:251], v227, s[24:27], s51 offen offset:8
  s_waitcnt vmcnt(0)
  v_xor_b32 v236, v236, v12
  v_xor_b32 v237, v237, v12
  v_xor_b32 v238, v238, v12
  v_xor_b32 v239, v239, v12
  v_xor_b32 v240, v240, v12
  v_xor_b32 v241, v241, v12
  v_xor_b32 v242, v242, v12
  v_xor_b32 v243, v243, v12
  ds_read_u16 v224, v236 offset:8192
  ds_read_u16 v225, v237 offset:8192
  ds_read_u16 v226, v238 offset:8192
  ds_read_u16 v227, v239 offset:8192
  ds_read_u16 v228, v240 offset:8192
  ds_read_u16 v229, v241 offset:8192
  ds_read_u16 v230, v242 offset:8192
  ds_read_u16 v231, v243 offset:8192
  v_xor_b32 v245, v245, v0
  v_xor_b32 v247, v247, v0
  v_xor_b32 v249, v249, v0
  v_xor_b32 v251, v251, v0
  s_waitcnt lgkmcnt(0)
  v_lshl_or_b32 v232, v225, 16, v224
  v_lshl_or_b32 v233, v227, 16, v226
  v_lshl_or_b32 v234, v229, 16, v228
  v_lshl_or_b32 v235, v231, 16, v230
  v_pk_min_u16 v228, v245, s64
  v_pk_add_u16 v228, v228, s65
  v_and_b32 v228, v228, v244
  v_pk_min_u16 v229, v247, s64
  v_pk_add_u16 v229, v229, s65
  v_and_b32 v229, v229, v246
  v_pk_min_u16 v230, v249, s64
  v_pk_add_u16 v230, v230, s65
  v_and_b32 v230, v230, v248
  v_pk_min_u16 v231, v251, s64
  v_pk_add_u16 v231, v231, s65
  v_and_b32 v231, v231, v250
  s_nop 1
  v_mfma_f32_16x16x32_bf16 v[64:67], v[228:231], v[232:235], v[64:67]
  s_nop 7
  v_xor_b32 v228, 262148, v245
  v_pk_min_u16 v228, v228, s64
  v_pk_add_u16 v228, v228, s65
  v_and_b32 v228, v228, v244
  v_xor_b32 v229, 262148, v247
  v_pk_min_u16 v229, v229, s64
  v_pk_add_u16 v229, v229, s65
  v_and_b32 v229, v229, v246
  v_xor_b32 v230, 262148, v249
  v_pk_min_u16 v230, v230, s64
  v_pk_add_u16 v230, v230, s65
  v_and_b32 v230, v230, v248
  v_xor_b32 v231, 262148, v251
  v_pk_min_u16 v231, v231, s64
  v_pk_add_u16 v231, v231, s65
  v_and_b32 v231, v231, v250
  s_nop 1
  v_mfma_f32_16x16x32_bf16 v[68:71], v[228:231], v[232:235], v[68:71]
  s_nop 7
  v_xor_b32 v228, 2097184, v245
  v_pk_min_u16 v228, v228, s64
  v_pk_add_u16 v228, v228, s65
  v_and_b32 v228, v228, v244
  v_xor_b32 v229, 2097184, v247
  v_pk_min_u16 v229, v229, s64
  v_pk_add_u16 v229, v229, s65
  v_and_b32 v229, v229, v246
  v_xor_b32 v230, 2097184, v249
  v_pk_min_u16 v230, v230, s64
  v_pk_add_u16 v230, v230, s65
  v_and_b32 v230, v230, v248
  v_xor_b32 v231, 2097184, v251
  v_pk_min_u16 v231, v231, s64
  v_pk_add_u16 v231, v231, s65
  v_and_b32 v231, v231, v250
  s_nop 1
  v_mfma_f32_16x16x32_bf16 v[72:75], v[228:231], v[232:235], v[72:75]
  s_nop 7
  v_xor_b32 v228, 2359332, v245
  v_pk_min_u16 v228, v228, s64
  v_pk_add_u16 v228, v228, s65
  v_and_b32 v228, v228, v244
  v_xor_b32 v229, 2359332, v247
  v_pk_min_u16 v229, v229, s64
  v_pk_add_u16 v229, v229, s65
  v_and_b32 v229, v229, v246
  v_xor_b32 v230, 2359332, v249
  v_pk_min_u16 v230, v230, s64
  v_pk_add_u16 v230, v230, s65
  v_and_b32 v230, v230, v248
  v_xor_b32 v231, 2359332, v251
  v_pk_min_u16 v231, v231, s64
  v_pk_add_u16 v231, v231, s65
  v_and_b32 v231, v231, v250
  s_nop 1
  v_mfma_f32_16x16x32_bf16 v[76:79], v[228:231], v[232:235], v[76:79]
  s_nop 7
  s_add_u32 s57, s57, 1
  s_cmp_lt_u32 s57, s39
  s_cbranch_scc1 Lslowloop_b3
  s_branch Lslowback_b3
Lslow_b4:
  s_mov_b32 s57, 4
Lslowloop_b4:
  v_mbcnt_lo_u32_b32 v13, -1, 0
  v_mbcnt_hi_u32_b32 v13, -1, v13
  s_lshl_b32 s52, s57, 4
  v_add_u32 v13, s52, v13
  v_lshlrev_b32 v254, 4, v13
  s_mov_b32 s44, -1
  s_add_u32 s44, s44, s80
  s_lshl_b32 s45, s80, 4
  s_sub_u32 s45, 16384, s45
  v_sub_u32 v15, s44, v13
  v_ashrrev_i32 v15, 31, v15
  v_and_b32 v15, s45, v15
  v_add_u32 v254, v254, v15
  s_add_u32 s44, s44, s81
  s_lshl_b32 s45, s81, 4
  s_sub_u32 s45, 16384, s45
  v_sub_u32 v15, s44, v13
  v_ashrrev_i32 v15, 31, v15
  v_and_b32 v15, s45, v15
  v_add_u32 v254, v254, v15
  s_add_u32 s44, s44, s82
  s_lshl_b32 s45, s82, 4
  s_sub_u32 s45, 16384, s45
  v_sub_u32 v15, s44, v13
  v_ashrrev_i32 v15, 31, v15
  v_and_b32 v15, s45, v15
  v_add_u32 v254, v254, v15
  s_add_u32 s44, s44, s83
  s_lshl_b32 s45, s83, 4
  s_sub_u32 s45, 16384, s45
  v_sub_u32 v15, s44, v13
  v_ashrrev_i32 v15, 31, v15
  v_and_b32 v15, s45, v15
  v_add_u32 v254, v254, v15
  s_add_u32 s44, s44, s84
  s_lshl_b32 s45, s84, 4
  s_sub_u32 s45, 16384, s45
  v_sub_u32 v15, s44, v13
  v_ashrrev_i32 v15, 31, v15
  v_and_b32 v15, s45, v15
  v_add_u32 v254, v254, v15
  s_add_u32 s44, s44, s85
  s_lshl_b32 s45, s85, 4
  s_sub_u32 s45, 16384, s45
  v_sub_u32 v15, s44, v13
  v_ashrrev_i32 v15, 31, v15
  v_and_b32 v15, s45, v15
  v_add_u32 v254, v254, v15
  s_add_u32 s44, s44, s86
  s_lshl_b32 s45, s86, 4
  s_sub_u32 s45, 16384, s45
  v_sub_u32 v15, s44, v13
  v_ashrrev_i32 v15, 31, v15
  v_and_b32 v15, s45, v15
  v_add_u32 v254, v254, v15
  s_add_u32 s44, s44, s87
  s_lshl_b32 s45, s87, 4
  s_sub_u32 s45, 16384, s45
  v_sub_u32 v15, s44, v13
  v_ashrrev_i32 v15, 31, v15
  v_and_b32 v15, s45, v15
  v_add_u32 v254, v254, v15
  s_add_u32 s44, s44, s88
  s_lshl_b32 s45, s88, 4
  s_sub_u32 s45, 16384, s45
  v_sub_u32 v15, s44, v13
  v_ashrrev_i32 v15, 31, v15
  v_and_b32 v15, s45, v15
  v_add_u32 v254, v254, v15
  s_add_u32 s44, s44, s89
  s_lshl_b32 s45, s89, 4
  s_sub_u32 s45, 16384, s45
  v_sub_u32 v15, s44, v13
  v_ashrrev_i32 v15, 31, v15
  v_and_b32 v15, s45, v15
  v_add_u32 v254, v254, v15
  s_add_u32 s44, s44, s90
  s_lshl_b32 s45, s90, 4
  s_sub_u32 s45, 16384, s45
  v_sub_u32 v15, s44, v13
  v_ashrrev_i32 v15, 31, v15
  v_and_b32 v15, s45, v15
  v_add_u32 v254, v254, v15
  s_add_u32 s44, s44, s91
  s_lshl_b32 s45, s91, 4
  s_sub_u32 s45, 16384, s45
  v_sub_u32 v15, s44, v13
  v_ashrrev_i32 v15, 31, v15
  v_and_b32 v15, s45, v15
  v_add_u32 v254, v254, v15
  s_add_u32 s44, s44, s92
  s_lshl_b32 s45, s92, 4
  s_sub_u32 s45, 16384, s45
  v_sub_u32 v15, s44, v13
  v_ashrrev_i32 v15, 31, v15
  v_and_b32 v15, s45, v15
  v_add_u32 v254, v254, v15
  s_add_u32 s44, s44, s93
  s_lshl_b32 s45, s93, 4
  s_sub_u32 s45, 16384, s45
  v_sub_u32 v15, s44, v13
  v_ashrrev_i32 v15, 31, v15
  v_and_b32 v15, s45, v15
  v_add_u32 v254, v254, v15
  s_add_u32 s44, s44, s94
  s_lshl_b32 s45, s94, 4
  s_sub_u32 s45, 16384, s45
  v_sub_u32 v15, s44, v13
  v_ashrrev_i32 v15, 31, v15
  v_and_b32 v15, s45, v15
  v_add_u32 v254, v254, v15
  s_add_u32 s44, s44, s95
  v_sub_u32 v15, s44, v13
  v_ashrrev_i32 v15, 31, v15
  v_and_b32 v15, 1073741824, v15
  v_or_b32 v254, v254, v15
  ds_bpermute_b32 v224, v252, v254 offset:0
  ds_bpermute_b32 v225, v252, v254 offset:4
  ds_bpermute_b32 v226, v252, v254 offset:8
  ds_bpermute_b32 v227, v252, v254 offset:12
  s_waitcnt lgkmcnt(0)
  buffer_load_dwordx2 v[236:237], v224, s[24:27], s51 offen
  buffer_load_dwordx2 v[244:245], v224, s[24:27], s51 offen offset:8
  buffer_load_dwordx2 v[238:239], v225, s[24:27], s51 offen
  buffer_load_dwordx2 v[246:247], v225, s[24:27], s51 offen offset:8
  buffer_load_dwordx2 v[240:241], v226, s[24:27], s51 offen
  buffer_load_dwordx2 v[248:249], v226, s[24:27], s51 offen offset:8
  buffer_load_dwordx2 v[242:243], v227, s[24:27], s51 offen
  buffer_load_dwordx2 v[250:251], v227, s[24:27], s51 offen offset:8
  s_waitcnt vmcnt(0)
  v_xor_b32 v236, v236, v12
  v_xor_b32 v237, v237, v12
  v_xor_b32 v238, v238, v12
  v_xor_b32 v239, v239, v12
  v_xor_b32 v240, v240, v12
  v_xor_b32 v241, v241, v12
  v_xor_b32 v242, v242, v12
  v_xor_b32 v243, v243, v12
  ds_read_u16 v224, v236 offset:0
  ds_read_u16 v225, v237 offset:0
  ds_read_u16 v226, v238 offset:0
  ds_read_u16 v227, v239 offset:0
  ds_read_u16 v228, v240 offset:0
  ds_read_u16 v229, v241 offset:0
  ds_read_u16 v230, v242 offset:0
  ds_read_u16 v231, v243 offset:0
  v_xor_b32 v245, v245, v0
  v_xor_b32 v247, v247, v0
  v_xor_b32 v249, v249, v0
  v_xor_b32 v251, v251, v0
  s_waitcnt lgkmcnt(0)
  v_lshl_or_b32 v232, v225, 16, v224
  v_lshl_or_b32 v233, v227, 16, v226
  v_lshl_or_b32 v234, v229, 16, v228
  v_lshl_or_b32 v235, v231, 16, v230
  v_pk_min_u16 v228, v245, s64
  v_pk_add_u16 v228, v228, s65
  v_and_b32 v228, v228, v244
  v_pk_min_u16 v229, v247, s64
  v_pk_add_u16 v229, v229, s65
  v_and_b32 v229, v229, v246
  v_pk_min_u16 v230, v249, s64
  v_pk_add_u16 v230, v230, s65
  v_and_b32 v230, v230, v248
  v_pk_min_u16 v231, v251, s64
  v_pk_add_u16 v231, v231, s65
  v_and_b32 v231, v231, v250
  s_nop 1
  v_mfma_f32_16x16x32_bf16 v[80:83], v[228:231], v[232:235], v[80:83]
  s_nop 7
  v_xor_b32 v228, 262148, v245
  v_pk_min_u16 v228, v228, s64
  v_pk_add_u16 v228, v228, s65
  v_and_b32 v228, v228, v244
  v_xor_b32 v229, 262148, v247
  v_pk_min_u16 v229, v229, s64
  v_pk_add_u16 v229, v229, s65
  v_and_b32 v229, v229, v246
  v_xor_b32 v230, 262148, v249
  v_pk_min_u16 v230, v230, s64
  v_pk_add_u16 v230, v230, s65
  v_and_b32 v230, v230, v248
  v_xor_b32 v231, 262148, v251
  v_pk_min_u16 v231, v231, s64
  v_pk_add_u16 v231, v231, s65
  v_and_b32 v231, v231, v250
  s_nop 1
  v_mfma_f32_16x16x32_bf16 v[84:87], v[228:231], v[232:235], v[84:87]
  s_nop 7
  v_xor_b32 v228, 2097184, v245
  v_pk_min_u16 v228, v228, s64
  v_pk_add_u16 v228, v228, s65
  v_and_b32 v228, v228, v244
  v_xor_b32 v229, 2097184, v247
  v_pk_min_u16 v229, v229, s64
  v_pk_add_u16 v229, v229, s65
  v_and_b32 v229, v229, v246
  v_xor_b32 v230, 2097184, v249
  v_pk_min_u16 v230, v230, s64
  v_pk_add_u16 v230, v230, s65
  v_and_b32 v230, v230, v248
  v_xor_b32 v231, 2097184, v251
  v_pk_min_u16 v231, v231, s64
  v_pk_add_u16 v231, v231, s65
  v_and_b32 v231, v231, v250
  s_nop 1
  v_mfma_f32_16x16x32_bf16 v[88:91], v[228:231], v[232:235], v[88:91]
  s_nop 7
  v_xor_b32 v228, 2359332, v245
  v_pk_min_u16 v228, v228, s64
  v_pk_add_u16 v228, v228, s65
  v_and_b32 v228, v228, v244
  v_xor_b32 v229, 2359332, v247
  v_pk_min_u16 v229, v229, s64
  v_pk_add_u16 v229, v229, s65
  v_and_b32 v229, v229, v246
  v_xor_b32 v230, 2359332, v249
  v_pk_min_u16 v230, v230, s64
  v_pk_add_u16 v230, v230, s65
  v_and_b32 v230, v230, v248
  v_xor_b32 v231, 2359332, v251
  v_pk_min_u16 v231, v231, s64
  v_pk_add_u16 v231, v231, s65
  v_and_b32 v231, v231, v250
  s_nop 1
  v_mfma_f32_16x16x32_bf16 v[92:95], v[228:231], v[232:235], v[92:95]
  s_nop 7
  s_add_u32 s57, s57, 1
  s_cmp_lt_u32 s57, s39
  s_cbranch_scc1 Lslowloop_b4
  s_branch Lslowback_b4
.section .rodata,"a"
.p2align 6
.amdhsa_kernel prep_kernel
  .amdhsa_next_free_vgpr 64
  .amdhsa_next_free_sgpr 64
  .amdhsa_accum_offset 64
  .amdhsa_group_segment_fixed_size 0
  .amdhsa_kernarg_size 48
  .amdhsa_user_sgpr_count 2
  .amdhsa_user_sgpr_kernarg_segment_ptr 1
  .amdhsa_system_sgpr_workgroup_id_x 1
.end_amdhsa_kernel
.p2align 6
.amdhsa_kernel standalone__structured_sparse_n_m__ragged_kernel
  .amdhsa_next_free_vgpr 512
  .amdhsa_next_free_sgpr 102
  .amdhsa_accum_offset 256
  .amdhsa_group_segment_fixed_size 0
  .amdhsa_kernarg_size 48
  .amdhsa_user_sgpr_count 2
  .amdhsa_user_sgpr_kernarg_segment_ptr 1
  .amdhsa_system_sgpr_workgroup_id_x 1
.end_amdhsa_kernel
```
